```python
import torch

def _softmax(x, axis=-1):
    return torch.softmax(x, dim=axis)
def _gelu(x):
    return torch.nn.functional.gelu(x, approximate="tanh")
def _silu(x):
    return torch.nn.functional.silu(x)
def _sigmoid(x):
    return torch.sigmoid(x)
def _layernorm(x, axis=-1, eps=1e-5):
    m = x.mean(dim=axis, keepdim=True)
    v = x.var(dim=axis, keepdim=True, unbiased=False)
    return (x - m) / torch.sqrt(v + eps)
def _scatter_add(tgt, idx, src, axis=0):
    return tgt.clone().index_add_(axis, idx, src)
def _segment_sum(src, seg, n):
    out = torch.zeros((n,) + src.shape[1:], dtype=src.dtype)
    return out.index_add_(0, seg, src)
def _pad(x, pw):
    flat = tuple(v for pair in reversed(pw) for v in pair)
    return torch.nn.functional.pad(x, flat)

kernel_name = 'sequential_preLN__sliding_block_cached__glu_gated_geglu__decode'

def setup_inputs():

    _w = (lambda a: (lambda t: t.to(torch.bfloat16) if t.is_floating_point() else t)(torch.as_tensor(a)))
    def _A_setup():
        B, Sq, D = 1, 1, 576
        Hq, Hkv, Sk, Dh = 32, 16, 65536, 128
        assert Hq % Hkv == 0, (Hq, Hkv)
        return {
            "x": _w((lambda *s: torch.randn(*s, dtype=torch.bfloat16) * 0.05)(B, Sq, D)),
            "k_cache": _w((lambda *s: torch.randn(*s, dtype=torch.bfloat16) * 1.6)(B, Hkv, Sk, Dh)),
            "v_cache": _w((lambda *s: torch.randn(*s, dtype=torch.bfloat16) * 0.8)(B, Hkv, Sk, Dh)),
            "wq": _w((lambda *s: torch.randn(*s, dtype=torch.bfloat16) * 1.6)(D, Hq * Dh) * (D ** -0.5)),
            "wo": _w((lambda *s: torch.randn(*s, dtype=torch.bfloat16) * 0.8)(Hq * Dh, D) * ((Hq * Dh) ** -0.5)),
        }
    _A_in = _A_setup()

    def _B_setup():
        B, S, Dm, Df = 1, 1, 576, 4608
        return {
            "x": _w((lambda *s: torch.randn(*s, dtype=torch.bfloat16) * 0.05)(B, S, Dm)),
            "w_gate": _w((lambda *s: torch.randn(*s, dtype=torch.bfloat16) * 0.4)(Dm, Df) * (Dm ** -0.5)),
            "w_up": _w((lambda *s: torch.randn(*s, dtype=torch.bfloat16) * 0.4)(Dm, Df) * (Dm ** -0.5)),
            "w_down": _w((lambda *s: torch.randn(*s, dtype=torch.bfloat16) * 0.4)(Df, Dm) * (Df ** -0.5)),
        }
    _B_in = _B_setup()

    return {
        "A_x": _A_in["x"],
        "A_k_cache": _A_in["k_cache"],
        "A_v_cache": _A_in["v_cache"],
        "A_wq": _A_in["wq"],
        "A_wo": _A_in["wo"],
        "B_x": _B_in["x"],
        "B_w_gate": _B_in["w_gate"],
        "B_w_up": _B_in["w_up"],
        "B_w_down": _B_in["w_down"],
    }

def reference(A_x, A_k_cache, A_v_cache, A_wq, A_wo, B_x, B_w_gate, B_w_up, B_w_down):
    def _A_ref(x, k_cache, v_cache, wq, wo):
        B, Sq, D = x.shape
        Hq, Dh = 32, 128
        Hkv, Sk = k_cache.shape[1], k_cache.shape[2]
        W = min(4096, max(256, Sk // 4))
        rep = Hq // Hkv
        q = (lambda x, *d: x.permute(*d))((x @ wq).reshape(B, Sq, Hq, Dh), 0, 2, 1, 3)
        k = (lambda x, n, axis: torch.repeat_interleave(x, n, dim=axis))(k_cache[:, :, Sk - W:, :], rep, axis=1)
        v = (lambda x, n, axis: torch.repeat_interleave(x, n, dim=axis))(v_cache[:, :, Sk - W:, :], rep, axis=1)
        scores = torch.einsum("bhqd,bhkd->bhqk", q, k) * (Dh ** -0.5)
        p = _softmax(scores, axis=-1)
        o = torch.einsum("bhqk,bhkd->bhqd", p, v)
        return (lambda x, *d: x.permute(*d))(o, 0, 2, 1, 3).reshape(B, Sq, Hq * Dh) @ wo

    def _B_ref(x, w_gate, w_up, w_down):
        g = torch.einsum("bsd,df->bsf", x, w_gate)
        u = torch.einsum("bsd,df->bsf", x, w_up)
        h = _gelu(g) * u
        return torch.einsum("bsf,fd->bsd", h, w_down)

    x = A_x
    h = x + _A_ref(_layernorm(x, axis=-1), A_k_cache, A_v_cache, A_wq, A_wo)
    h2 = h + _B_ref(_layernorm(h, axis=-1), B_w_gate, B_w_up, B_w_down)
    return h2
```

```asm
; @launch grid=(256,1,1) block=(320,1,1) lds=163840
.amdgcn_target "amdgcn-amd-amdhsa--gfx950"
.set CODE_KB, 16
.set CODE_BYTES, 16640
.text
.globl sequential_preLN__sliding_block_cached__glu_gated_geglu__decode_kernel
.p2align 8
.type sequential_preLN__sliding_block_cached__glu_gated_geglu__decode_kernel,@function
sequential_preLN__sliding_block_cached__glu_gated_geglu__decode_kernel:
  s_cmp_ge_u32 s2, 256
  s_cbranch_scc1 L_end
  s_load_dwordx16 s[4:19], s[0:1], 0
  s_load_dwordx8 s[20:27], s[0:1], 64
  v_lshrrev_b32 v2, 6, v0
  v_and_b32 v1, 63, v0
  s_and_b32 s28, s2, 7
  v_readfirstlane_b32 s3, v2
  s_lshr_b32 s29, s2, 3
  s_lshr_b32 s30, s29, 4
  s_lshl_b32 s31, s28, 1
  s_add_u32 s30, s30, s31
  s_and_b32 s31, s29, 15
  s_mov_b32 s50, 2000000
  v_mov_b32 v4, 149504
  s_cmp_eq_u32 s3, 0
  s_cbranch_scc0 L_compute
  s_setprio 3
  v_mov_b32 v6, 0
  v_mov_b32 v7, 0
  v_lshl_add_u32 v5, v1, 3, v4
  ds_write_b64 v5, v[6:7]
  v_lshrrev_b32 v2, 3, v1
  v_and_b32 v3, 7, v1
  v_bfe_u32 v8, v2, 1, 2
  v_lshlrev_b32 v8, 1, v8
  v_xor_b32 v3, v3, v8
  v_lshlrev_b32 v3, 4, v3
  v_lshl_add_u32 v10, v2, 13, v3
  v_mul_u32_u24 v8, 1152, v2
  v_add_u32 v11, v8, v3
  v_xor_b32 v19, 64, v11
  v_mul_u32_u24 v8, 9216, v2
  v_add_u32 v18, v8, v3
  v_lshrrev_b32 v2, 4, v1
  v_and_b32 v3, 15, v1
  v_xor_b32 v8, v3, v2
  v_lshlrev_b32 v8, 4, v8
  v_lshl_add_u32 v12, v2, 8, v8
  v_xor_b32 v13, 64, v12
  v_xor_b32 v14, 0x80, v12
  v_xor_b32 v15, 0xc0, v12
  v_lshlrev_b32 v8, 1, v2
  v_xor_b32 v8, v3, v8
  v_lshlrev_b32 v8, 4, v8
  v_lshl_add_u32 v16, v2, 8, v8
  v_xor_b32 v17, 0x80, v16
  v_lshl_add_u32 v21, v1, 2, v4
  s_lshr_b32 s64, s31, 2
  s_mul_i32 s64, s64, 1179648
  s_and_b32 s65, s31, 3
  s_lshl_b32 s65, s65, 7
  s_add_u32 s64, s64, s65
  s_lshl_b32 s65, s30, 9
  s_add_u32 s64, s64, s65
  s_lshl_b32 s65, s30, 24
  s_add_u32 s65, s65, 15728640
  s_lshl_b32 s66, s31, 16
  s_add_u32 s65, s65, s66
  s_mov_b32 s69, 0
  s_mov_b32 m0, 0
  s_mov_b32 s46, 4718592
  s_mov_b32 s47, 0x20000
  s_waitcnt lgkmcnt(0)
  s_mov_b32 s44, s10
  s_mov_b32 s45, s11
  s_mov_b32 s67, 5
Ll_1:
  buffer_load_dwordx4 v10, s[44:47], s64 offen offset:0 nt lds
  s_add_u32 m0, m0, 1024
  s_add_u32 s64, s64, 65536
  buffer_load_dwordx4 v10, s[44:47], s64 offen offset:0 nt lds
  s_add_u32 m0, m0, 1024
  s_add_u32 s64, s64, 65536
  buffer_load_dwordx4 v10, s[44:47], s64 offen offset:0 nt lds
  s_add_u32 m0, m0, 1024
  s_add_u32 s64, s64, 65536
  s_sub_u32 s67, s67, 1
  s_cbranch_scc0 Ll_1
  s_barrier
  s_cmp_lt_u32 s29, 18
  s_cbranch_scc1 L_ldA
  s_cmp_lt_u32 s29, 27
  s_cbranch_scc1 L_ldS0
L_ldA:
  v_mov_b32 v20, -5
  s_mov_b32 s44, s6
  s_mov_b32 s45, s7
  s_mov_b32 s46, 268435456
  s_mov_b32 s47, 0x20000
  s_mov_b32 m0, 18432
  s_mov_b32 s68, s69
  s_mov_b32 s67, 15
Ll_2:
  s_add_u32 s66, s65, s68
  buffer_load_dwordx4 v12, s[44:47], s66 offen offset:0 nt lds
  s_waitcnt vmcnt(23)
  v_add_u32 v20, 1, v20
  ds_write_b32 v21, v20
  buffer_load_dwordx4 v13, s[44:47], s66 offen offset:1024 nt lds
  s_waitcnt vmcnt(23)
  v_add_u32 v20, 1, v20
  ds_write_b32 v21, v20
  buffer_load_dwordx4 v14, s[44:47], s66 offen offset:2048 nt lds
  s_waitcnt vmcnt(23)
  v_add_u32 v20, 1, v20
  ds_write_b32 v21, v20
  buffer_load_dwordx4 v15, s[44:47], s66 offen offset:3072 nt lds
  s_waitcnt vmcnt(23)
  v_add_u32 v20, 1, v20
  ds_write_b32 v21, v20
  s_add_u32 m0, m0, 4096
  s_add_u32 s68, s68, 4096
  s_and_b32 s68, s68, 0xffff
  s_sub_u32 s67, s67, 1
  s_cbranch_scc0 Ll_2
  s_mov_b32 s44, s8
  s_mov_b32 s45, s9
  s_mov_b32 s46, 268435456
  s_mov_b32 s47, 0x20000
  s_mov_b32 m0, 83968
  s_mov_b32 s68, s69
  s_mov_b32 s67, 15
Ll_3:
  s_add_u32 s66, s65, s68
  buffer_load_dwordx4 v16, s[44:47], s66 offen offset:0 nt lds
  s_waitcnt vmcnt(23)
  v_add_u32 v20, 1, v20
  ds_write_b32 v21, v20
  buffer_load_dwordx4 v17, s[44:47], s66 offen offset:1024 nt lds
  s_waitcnt vmcnt(23)
  v_add_u32 v20, 1, v20
  ds_write_b32 v21, v20
  buffer_load_dwordx4 v16, s[44:47], s66 offen offset:2048 nt lds
  s_waitcnt vmcnt(23)
  v_add_u32 v20, 1, v20
  ds_write_b32 v21, v20
  buffer_load_dwordx4 v17, s[44:47], s66 offen offset:3072 nt lds
  s_waitcnt vmcnt(23)
  v_add_u32 v20, 1, v20
  ds_write_b32 v21, v20
  s_add_u32 m0, m0, 4096
  s_add_u32 s68, s68, 4096
  s_and_b32 s68, s68, 0xffff
  s_sub_u32 s67, s67, 1
  s_cbranch_scc0 Ll_3
  s_cmp_lt_u32 s29, 18
  s_cbranch_scc1 L_ldF
  s_waitcnt vmcnt(22)
  v_add_u32 v20, 1, v20
  ds_write_b32 v21, v20
  s_waitcnt vmcnt(21)
  v_add_u32 v20, 1, v20
  ds_write_b32 v21, v20
  s_waitcnt vmcnt(20)
  v_add_u32 v20, 1, v20
  ds_write_b32 v21, v20
  s_waitcnt vmcnt(19)
  v_add_u32 v20, 1, v20
  ds_write_b32 v21, v20
  s_waitcnt vmcnt(18)
  v_add_u32 v20, 1, v20
  ds_write_b32 v21, v20
  s_waitcnt vmcnt(17)
  v_add_u32 v20, 1, v20
  ds_write_b32 v21, v20
  s_waitcnt vmcnt(16)
  v_add_u32 v20, 1, v20
  ds_write_b32 v21, v20
  s_waitcnt vmcnt(15)
  v_add_u32 v20, 1, v20
  ds_write_b32 v21, v20
  s_waitcnt vmcnt(14)
  v_add_u32 v20, 1, v20
  ds_write_b32 v21, v20
  s_waitcnt vmcnt(13)
  v_add_u32 v20, 1, v20
  ds_write_b32 v21, v20
  s_waitcnt vmcnt(12)
  v_add_u32 v20, 1, v20
  ds_write_b32 v21, v20
  s_waitcnt vmcnt(11)
  v_add_u32 v20, 1, v20
  ds_write_b32 v21, v20
  s_waitcnt vmcnt(10)
  v_add_u32 v20, 1, v20
  ds_write_b32 v21, v20
  s_waitcnt vmcnt(9)
  v_add_u32 v20, 1, v20
  ds_write_b32 v21, v20
  s_waitcnt vmcnt(8)
  v_add_u32 v20, 1, v20
  ds_write_b32 v21, v20
  s_waitcnt vmcnt(7)
  v_add_u32 v20, 1, v20
  ds_write_b32 v21, v20
  s_waitcnt vmcnt(6)
  v_add_u32 v20, 1, v20
  ds_write_b32 v21, v20
  s_waitcnt vmcnt(5)
  v_add_u32 v20, 1, v20
  ds_write_b32 v21, v20
  s_waitcnt vmcnt(4)
  v_add_u32 v20, 1, v20
  ds_write_b32 v21, v20
  s_waitcnt vmcnt(3)
  v_add_u32 v20, 1, v20
  ds_write_b32 v21, v20
  s_waitcnt vmcnt(2)
  v_add_u32 v20, 1, v20
  ds_write_b32 v21, v20
  s_waitcnt vmcnt(1)
  v_add_u32 v20, 1, v20
  ds_write_b32 v21, v20
  s_waitcnt vmcnt(0)
  v_add_u32 v20, 1, v20
  ds_write_b32 v21, v20
  s_branch L_ldEnd
L_ldS0:
  v_mov_b32 v20, -17
  s_mov_b32 s44, s6
  s_mov_b32 s45, s7
  s_mov_b32 s46, 268435456
  s_mov_b32 s47, 0x20000
  s_mov_b32 m0, 18432
  s_mov_b32 s68, s69
  s_mov_b32 s67, 15
Ll_4:
  s_add_u32 s66, s65, s68
  buffer_load_dwordx4 v12, s[44:47], s66 offen offset:0 nt lds
  s_waitcnt vmcnt(35)
  v_add_u32 v20, 1, v20
  ds_write_b32 v21, v20
  buffer_load_dwordx4 v13, s[44:47], s66 offen offset:1024 nt lds
  s_waitcnt vmcnt(35)
  v_add_u32 v20, 1, v20
  ds_write_b32 v21, v20
  buffer_load_dwordx4 v14, s[44:47], s66 offen offset:2048 nt lds
  s_waitcnt vmcnt(35)
  v_add_u32 v20, 1, v20
  ds_write_b32 v21, v20
  buffer_load_dwordx4 v15, s[44:47], s66 offen offset:3072 nt lds
  s_waitcnt vmcnt(35)
  v_add_u32 v20, 1, v20
  ds_write_b32 v21, v20
  s_add_u32 m0, m0, 4096
  s_add_u32 s68, s68, 4096
  s_and_b32 s68, s68, 0xffff
  s_sub_u32 s67, s67, 1
  s_cbranch_scc0 Ll_4
  s_mov_b32 s44, s8
  s_mov_b32 s45, s9
  s_mov_b32 s46, 268435456
  s_mov_b32 s47, 0x20000
  s_mov_b32 m0, 83968
  s_mov_b32 s68, s69
  s_mov_b32 s67, 15
Ll_5:
  s_add_u32 s66, s65, s68
  buffer_load_dwordx4 v16, s[44:47], s66 offen offset:0 nt lds
  s_waitcnt vmcnt(35)
  v_add_u32 v20, 1, v20
  ds_write_b32 v21, v20
  buffer_load_dwordx4 v17, s[44:47], s66 offen offset:1024 nt lds
  s_waitcnt vmcnt(35)
  v_add_u32 v20, 1, v20
  ds_write_b32 v21, v20
  buffer_load_dwordx4 v16, s[44:47], s66 offen offset:2048 nt lds
  s_waitcnt vmcnt(35)
  v_add_u32 v20, 1, v20
  ds_write_b32 v21, v20
  buffer_load_dwordx4 v17, s[44:47], s66 offen offset:3072 nt lds
  s_waitcnt vmcnt(35)
  v_add_u32 v20, 1, v20
  ds_write_b32 v21, v20
  s_add_u32 m0, m0, 4096
  s_add_u32 s68, s68, 4096
  s_and_b32 s68, s68, 0xffff
  s_sub_u32 s67, s67, 1
  s_cbranch_scc0 Ll_5
Lw_6:
  ds_read_b32 v22, v4 offset:256
  s_waitcnt lgkmcnt(0)
  v_readfirstlane_b32 s51, v22
  s_nop 0
  s_cmp_ge_i32 s51, 4
  s_cbranch_scc1 Lw_6d
  s_sub_u32 s50, s50, 1
  s_cbranch_scc0 Lw_6
  s_mov_b32 s50, 0
Lw_6d:
  s_mov_b32 s44, s12
  s_mov_b32 s45, s13
  s_mov_b32 s46, 4718592
  s_mov_b32 s47, 0x20000
  s_sub_u32 s66, s29, 18
  s_lshl_b32 s66, s66, 7
  s_mul_i32 s68, s28, 589824
  s_add_u32 s66, s66, s68
  s_mov_b32 m0, 0
  v_lshrrev_b32 v2, 3, v1
  v_and_b32 v3, 7, v1
  v_bfe_u32 v8, v2, 1, 1
  v_lshlrev_b32 v8, 1, v8
  v_xor_b32 v3, v3, v8
  v_lshlrev_b32 v3, 4, v3
  v_mul_u32_u24 v8, 1152, v2
  v_add_u32 v24, v8, v3
  v_xor_b32 v23, 64, v24
  buffer_load_dwordx4 v24, s[44:47], s66 offen offset:0 nt lds
  s_add_u32 m0, m0, 1024
  s_add_u32 s66, s66, 9216
  buffer_load_dwordx4 v24, s[44:47], s66 offen offset:0 nt lds
  s_add_u32 m0, m0, 1024
  s_add_u32 s66, s66, 9216
  buffer_load_dwordx4 v23, s[44:47], s66 offen offset:0 nt lds
  s_add_u32 m0, m0, 1024
  s_add_u32 s66, s66, 9216
  buffer_load_dwordx4 v23, s[44:47], s66 offen offset:0 nt lds
  s_add_u32 m0, m0, 1024
  s_add_u32 s66, s66, 9216
  s_mov_b32 s67, 14
Ll_7:
  buffer_load_dwordx4 v24, s[44:47], s66 offen offset:0 nt lds
  s_waitcnt vmcnt(39)
  v_add_u32 v20, 1, v20
  ds_write_b32 v21, v20
  s_add_u32 m0, m0, 1024
  s_add_u32 s66, s66, 9216
  buffer_load_dwordx4 v24, s[44:47], s66 offen offset:0 nt lds
  s_waitcnt vmcnt(39)
  v_add_u32 v20, 1, v20
  ds_write_b32 v21, v20
  s_add_u32 m0, m0, 1024
  s_add_u32 s66, s66, 9216
  buffer_load_dwordx4 v23, s[44:47], s66 offen offset:0 nt lds
  s_waitcnt vmcnt(39)
  v_add_u32 v20, 1, v20
  ds_write_b32 v21, v20
  s_add_u32 m0, m0, 1024
  s_add_u32 s66, s66, 9216
  buffer_load_dwordx4 v23, s[44:47], s66 offen offset:0 nt lds
  s_waitcnt vmcnt(39)
  v_add_u32 v20, 1, v20
  ds_write_b32 v21, v20
  s_add_u32 m0, m0, 1024
  s_add_u32 s66, s66, 9216
  s_sub_u32 s67, s67, 1
  s_cbranch_scc0 Ll_7
  s_waitcnt vmcnt(38)
  v_add_u32 v20, 1, v20
  ds_write_b32 v21, v20
  s_waitcnt vmcnt(37)
  v_add_u32 v20, 1, v20
  ds_write_b32 v21, v20
  s_waitcnt vmcnt(36)
  v_add_u32 v20, 1, v20
  ds_write_b32 v21, v20
  s_waitcnt vmcnt(35)
  v_add_u32 v20, 1, v20
  ds_write_b32 v21, v20
  s_waitcnt vmcnt(34)
  v_add_u32 v20, 1, v20
  ds_write_b32 v21, v20
  s_waitcnt vmcnt(33)
  v_add_u32 v20, 1, v20
  ds_write_b32 v21, v20
  s_waitcnt vmcnt(32)
  v_add_u32 v20, 1, v20
  ds_write_b32 v21, v20
  s_waitcnt vmcnt(31)
  v_add_u32 v20, 1, v20
  ds_write_b32 v21, v20
  s_waitcnt vmcnt(30)
  v_add_u32 v20, 1, v20
  ds_write_b32 v21, v20
  s_waitcnt vmcnt(29)
  v_add_u32 v20, 1, v20
  ds_write_b32 v21, v20
  s_waitcnt vmcnt(28)
  v_add_u32 v20, 1, v20
  ds_write_b32 v21, v20
  s_waitcnt vmcnt(27)
  v_add_u32 v20, 1, v20
  ds_write_b32 v21, v20
  s_waitcnt vmcnt(26)
  v_add_u32 v20, 1, v20
  ds_write_b32 v21, v20
  s_waitcnt vmcnt(25)
  v_add_u32 v20, 1, v20
  ds_write_b32 v21, v20
  s_waitcnt vmcnt(24)
  v_add_u32 v20, 1, v20
  ds_write_b32 v21, v20
  s_waitcnt vmcnt(23)
  v_add_u32 v20, 1, v20
  ds_write_b32 v21, v20
  s_waitcnt vmcnt(22)
  v_add_u32 v20, 1, v20
  ds_write_b32 v21, v20
  s_waitcnt vmcnt(21)
  v_add_u32 v20, 1, v20
  ds_write_b32 v21, v20
  s_waitcnt vmcnt(20)
  v_add_u32 v20, 1, v20
  ds_write_b32 v21, v20
  s_waitcnt vmcnt(19)
  v_add_u32 v20, 1, v20
  ds_write_b32 v21, v20
  s_waitcnt vmcnt(18)
  v_add_u32 v20, 1, v20
  ds_write_b32 v21, v20
  s_waitcnt vmcnt(17)
  v_add_u32 v20, 1, v20
  ds_write_b32 v21, v20
  s_waitcnt vmcnt(16)
  v_add_u32 v20, 1, v20
  ds_write_b32 v21, v20
  s_waitcnt vmcnt(15)
  v_add_u32 v20, 1, v20
  ds_write_b32 v21, v20
  s_waitcnt vmcnt(14)
  v_add_u32 v20, 1, v20
  ds_write_b32 v21, v20
  s_waitcnt vmcnt(13)
  v_add_u32 v20, 1, v20
  ds_write_b32 v21, v20
  s_waitcnt vmcnt(12)
  v_add_u32 v20, 1, v20
  ds_write_b32 v21, v20
  s_waitcnt vmcnt(11)
  v_add_u32 v20, 1, v20
  ds_write_b32 v21, v20
  s_waitcnt vmcnt(10)
  v_add_u32 v20, 1, v20
  ds_write_b32 v21, v20
  s_waitcnt vmcnt(9)
  v_add_u32 v20, 1, v20
  ds_write_b32 v21, v20
  s_waitcnt vmcnt(8)
  v_add_u32 v20, 1, v20
  ds_write_b32 v21, v20
  s_waitcnt vmcnt(7)
  v_add_u32 v20, 1, v20
  ds_write_b32 v21, v20
  s_waitcnt vmcnt(6)
  v_add_u32 v20, 1, v20
  ds_write_b32 v21, v20
  s_waitcnt vmcnt(5)
  v_add_u32 v20, 1, v20
  ds_write_b32 v21, v20
  s_waitcnt vmcnt(4)
  v_add_u32 v20, 1, v20
  ds_write_b32 v21, v20
  s_waitcnt vmcnt(3)
  v_add_u32 v20, 1, v20
  ds_write_b32 v21, v20
  s_waitcnt vmcnt(2)
  v_add_u32 v20, 1, v20
  ds_write_b32 v21, v20
  s_waitcnt vmcnt(1)
  v_add_u32 v20, 1, v20
  ds_write_b32 v21, v20
  s_waitcnt vmcnt(0)
  v_add_u32 v20, 1, v20
  ds_write_b32 v21, v20
  s_branch L_ldEnd
L_ldF:
Lw_8:
  ds_read_b32 v22, v4 offset:256
  s_waitcnt lgkmcnt(0)
  v_readfirstlane_b32 s51, v22
  s_nop 0
  s_cmp_ge_i32 s51, 4
  s_cbranch_scc1 Lw_8d
  s_sub_u32 s50, s50, 1
  s_cbranch_scc0 Lw_8
  s_mov_b32 s50, 0
Lw_8d:
  s_mov_b32 s44, s16
  s_mov_b32 s45, s17
  s_mov_b32 s46, 5308416
  s_mov_b32 s47, 0x20000
  s_bitcmp1_b32 s29, 0
  s_cselect_b32 s44, s18, s16
  s_cselect_b32 s45, s19, s17
  s_lshr_b32 s68, s29, 1
  s_mul_i32 s69, s28, 9
  s_add_u32 s68, s68, s69
  s_lshl_b32 s66, s68, 7
  s_mov_b32 m0, 0
  s_waitcnt vmcnt(22)
  v_add_u32 v20, 1, v20
  ds_write_b32 v21, v20
  s_waitcnt vmcnt(21)
  v_add_u32 v20, 1, v20
  ds_write_b32 v21, v20
  s_waitcnt vmcnt(20)
  v_add_u32 v20, 1, v20
  ds_write_b32 v21, v20
  s_waitcnt vmcnt(19)
  v_add_u32 v20, 1, v20
  ds_write_b32 v21, v20
  s_waitcnt vmcnt(18)
  v_add_u32 v20, 1, v20
  ds_write_b32 v21, v20
  s_waitcnt vmcnt(17)
  v_add_u32 v20, 1, v20
  ds_write_b32 v21, v20
  s_waitcnt vmcnt(16)
  v_add_u32 v20, 1, v20
  ds_write_b32 v21, v20
  s_waitcnt vmcnt(15)
  v_add_u32 v20, 1, v20
  ds_write_b32 v21, v20
  s_mov_b32 s67, 23
Ll_9:
  buffer_load_dwordx4 v18, s[44:47], s66 offen offset:0 nt lds
  s_waitcnt vmcnt(15)
  v_add_u32 v20, 1, v20
  ds_write_b32 v21, v20
  s_add_u32 m0, m0, 1024
  s_add_u32 s66, s66, 73728
  s_sub_u32 s67, s67, 1
  s_cbranch_scc0 Ll_9
  buffer_load_dwordx4 v18, s[44:47], s66 offen offset:0 nt lds
  s_add_u32 m0, m0, 1024
  s_add_u32 s66, s66, 73728
  buffer_load_dwordx4 v18, s[44:47], s66 offen offset:0 nt lds
  s_add_u32 m0, m0, 1024
  s_add_u32 s66, s66, 73728
  buffer_load_dwordx4 v18, s[44:47], s66 offen offset:0 nt lds
  s_add_u32 m0, m0, 1024
  s_add_u32 s66, s66, 73728
  buffer_load_dwordx4 v18, s[44:47], s66 offen offset:0 nt lds
  s_add_u32 m0, m0, 1024
  s_add_u32 s66, s66, 73728
  buffer_load_dwordx4 v18, s[44:47], s66 offen offset:0 nt lds
  s_add_u32 m0, m0, 1024
  s_add_u32 s66, s66, 73728
  buffer_load_dwordx4 v18, s[44:47], s66 offen offset:0 nt lds
  s_add_u32 m0, m0, 1024
  s_add_u32 s66, s66, 73728
  buffer_load_dwordx4 v18, s[44:47], s66 offen offset:0 nt lds
  s_add_u32 m0, m0, 1024
  s_add_u32 s66, s66, 73728
  buffer_load_dwordx4 v18, s[44:47], s66 offen offset:0 nt lds
  s_add_u32 m0, m0, 1024
  s_add_u32 s66, s66, 73728
  buffer_load_dwordx4 v18, s[44:47], s66 offen offset:0 nt lds
  s_add_u32 m0, m0, 1024
  s_add_u32 s66, s66, 73728
  buffer_load_dwordx4 v18, s[44:47], s66 offen offset:0 nt lds
  s_add_u32 m0, m0, 1024
  s_add_u32 s66, s66, 73728
  buffer_load_dwordx4 v18, s[44:47], s66 offen offset:0 nt lds
  s_add_u32 m0, m0, 1024
  s_add_u32 s66, s66, 73728
  buffer_load_dwordx4 v18, s[44:47], s66 offen offset:0 nt lds
  s_add_u32 m0, m0, 1024
  s_add_u32 s66, s66, 73728
  buffer_load_dwordx4 v18, s[44:47], s66 offen offset:0 nt lds
  s_add_u32 m0, m0, 1024
  s_add_u32 s66, s66, 73728
  buffer_load_dwordx4 v18, s[44:47], s66 offen offset:0 nt lds
  s_add_u32 m0, m0, 1024
  s_add_u32 s66, s66, 73728
  buffer_load_dwordx4 v18, s[44:47], s66 offen offset:0 nt lds
  s_add_u32 m0, m0, 1024
  s_add_u32 s66, s66, 73728
  buffer_load_dwordx4 v18, s[44:47], s66 offen offset:0 nt lds
  s_add_u32 m0, m0, 1024
  s_add_u32 s66, s66, 73728
  buffer_load_dwordx4 v18, s[44:47], s66 offen offset:0 nt lds
  s_add_u32 m0, m0, 1024
  s_add_u32 s66, s66, 73728
  buffer_load_dwordx4 v18, s[44:47], s66 offen offset:0 nt lds
  s_add_u32 m0, m0, 1024
  s_add_u32 s66, s66, 73728
  buffer_load_dwordx4 v18, s[44:47], s66 offen offset:0 nt lds
  s_add_u32 m0, m0, 1024
  s_add_u32 s66, s66, 73728
  buffer_load_dwordx4 v18, s[44:47], s66 offen offset:0 nt lds
  s_add_u32 m0, m0, 1024
  s_add_u32 s66, s66, 73728
  buffer_load_dwordx4 v18, s[44:47], s66 offen offset:0 nt lds
  s_add_u32 m0, m0, 1024
  s_add_u32 s66, s66, 73728
  buffer_load_dwordx4 v18, s[44:47], s66 offen offset:0 nt lds
  s_add_u32 m0, m0, 1024
  s_add_u32 s66, s66, 73728
  buffer_load_dwordx4 v18, s[44:47], s66 offen offset:0 nt lds
  s_add_u32 m0, m0, 1024
  s_add_u32 s66, s66, 73728
  buffer_load_dwordx4 v18, s[44:47], s66 offen offset:0 nt lds
  s_add_u32 m0, m0, 1024
  s_add_u32 s66, s66, 73728
  s_mov_b32 s67, 23
Ll_10:
  buffer_load_dwordx4 v18, s[44:47], s66 offen offset:0 nt lds
  s_waitcnt vmcnt(39)
  v_add_u32 v20, 1, v20
  ds_write_b32 v21, v20
  s_add_u32 m0, m0, 1024
  s_add_u32 s66, s66, 73728
  s_sub_u32 s67, s67, 1
  s_cbranch_scc0 Ll_10
Lw_11:
  ds_read_b32 v22, v4 offset:260
  s_waitcnt lgkmcnt(0)
  v_readfirstlane_b32 s51, v22
  s_nop 0
  s_cmp_ge_i32 s51, 4
  s_cbranch_scc1 Lw_11d
  s_sub_u32 s50, s50, 1
  s_cbranch_scc0 Lw_11
  s_mov_b32 s50, 0
Lw_11d:
  s_mov_b32 s44, s20
  s_mov_b32 s45, s21
  s_mov_b32 s46, 5308416
  s_mov_b32 s47, 0x20000
  s_and_b32 s69, s29, 1
  s_lshl_b32 s69, s69, 3
  s_lshl_b32 s68, s68, 6
  s_add_u32 s68, s68, s69
  s_mul_i32 s66, s68, 1152
  s_mov_b32 m0, 83968
  s_mov_b32 s67, 8
Ll_12:
  s_add_u32 s68, s66, 0
  buffer_load_dwordx4 v11, s[44:47], s68 offen offset:0 nt lds
  s_waitcnt vmcnt(39)
  v_add_u32 v20, 1, v20
  ds_write_b32 v21, v20
  s_add_u32 m0, m0, 1024
  s_add_u32 s68, s66, 18432
  buffer_load_dwordx4 v19, s[44:47], s68 offen offset:0 nt lds
  s_waitcnt vmcnt(39)
  v_add_u32 v20, 1, v20
  ds_write_b32 v21, v20
  s_add_u32 m0, m0, 1024
  s_add_u32 s68, s66, 36864
  buffer_load_dwordx4 v11, s[44:47], s68 offen offset:0 nt lds
  s_waitcnt vmcnt(39)
  v_add_u32 v20, 1, v20
  ds_write_b32 v21, v20
  s_add_u32 m0, m0, 1024
  s_add_u32 s68, s66, 55296
  buffer_load_dwordx4 v19, s[44:47], s68 offen offset:0 nt lds
  s_waitcnt vmcnt(39)
  v_add_u32 v20, 1, v20
  ds_write_b32 v21, v20
  s_add_u32 m0, m0, 1024
  s_add_u32 s66, s66, 128
  s_sub_u32 s67, s67, 1
  s_cbranch_scc0 Ll_12
  s_waitcnt vmcnt(38)
  v_add_u32 v20, 1, v20
  ds_write_b32 v21, v20
  s_waitcnt vmcnt(37)
  v_add_u32 v20, 1, v20
  ds_write_b32 v21, v20
  s_waitcnt vmcnt(36)
  v_add_u32 v20, 1, v20
  ds_write_b32 v21, v20
  s_waitcnt vmcnt(35)
  v_add_u32 v20, 1, v20
  ds_write_b32 v21, v20
  s_waitcnt vmcnt(34)
  v_add_u32 v20, 1, v20
  ds_write_b32 v21, v20
  s_waitcnt vmcnt(33)
  v_add_u32 v20, 1, v20
  ds_write_b32 v21, v20
  s_waitcnt vmcnt(32)
  v_add_u32 v20, 1, v20
  ds_write_b32 v21, v20
  s_waitcnt vmcnt(31)
  v_add_u32 v20, 1, v20
  ds_write_b32 v21, v20
  s_waitcnt vmcnt(30)
  v_add_u32 v20, 1, v20
  ds_write_b32 v21, v20
  s_waitcnt vmcnt(29)
  v_add_u32 v20, 1, v20
  ds_write_b32 v21, v20
  s_waitcnt vmcnt(28)
  v_add_u32 v20, 1, v20
  ds_write_b32 v21, v20
  s_waitcnt vmcnt(27)
  v_add_u32 v20, 1, v20
  ds_write_b32 v21, v20
  s_waitcnt vmcnt(26)
  v_add_u32 v20, 1, v20
  ds_write_b32 v21, v20
  s_waitcnt vmcnt(25)
  v_add_u32 v20, 1, v20
  ds_write_b32 v21, v20
  s_waitcnt vmcnt(24)
  v_add_u32 v20, 1, v20
  ds_write_b32 v21, v20
  s_waitcnt vmcnt(23)
  v_add_u32 v20, 1, v20
  ds_write_b32 v21, v20
  s_waitcnt vmcnt(22)
  v_add_u32 v20, 1, v20
  ds_write_b32 v21, v20
  s_waitcnt vmcnt(21)
  v_add_u32 v20, 1, v20
  ds_write_b32 v21, v20
  s_waitcnt vmcnt(20)
  v_add_u32 v20, 1, v20
  ds_write_b32 v21, v20
  s_waitcnt vmcnt(19)
  v_add_u32 v20, 1, v20
  ds_write_b32 v21, v20
  s_waitcnt vmcnt(18)
  v_add_u32 v20, 1, v20
  ds_write_b32 v21, v20
  s_waitcnt vmcnt(17)
  v_add_u32 v20, 1, v20
  ds_write_b32 v21, v20
  s_waitcnt vmcnt(16)
  v_add_u32 v20, 1, v20
  ds_write_b32 v21, v20
  s_waitcnt vmcnt(15)
  v_add_u32 v20, 1, v20
  ds_write_b32 v21, v20
  s_waitcnt vmcnt(14)
  v_add_u32 v20, 1, v20
  ds_write_b32 v21, v20
  s_waitcnt vmcnt(13)
  v_add_u32 v20, 1, v20
  ds_write_b32 v21, v20
  s_waitcnt vmcnt(12)
  v_add_u32 v20, 1, v20
  ds_write_b32 v21, v20
  s_waitcnt vmcnt(11)
  v_add_u32 v20, 1, v20
  ds_write_b32 v21, v20
  s_waitcnt vmcnt(10)
  v_add_u32 v20, 1, v20
  ds_write_b32 v21, v20
  s_waitcnt vmcnt(9)
  v_add_u32 v20, 1, v20
  ds_write_b32 v21, v20
  s_waitcnt vmcnt(8)
  v_add_u32 v20, 1, v20
  ds_write_b32 v21, v20
  s_waitcnt vmcnt(7)
  v_add_u32 v20, 1, v20
  ds_write_b32 v21, v20
  s_waitcnt vmcnt(6)
  v_add_u32 v20, 1, v20
  ds_write_b32 v21, v20
  s_waitcnt vmcnt(5)
  v_add_u32 v20, 1, v20
  ds_write_b32 v21, v20
  s_waitcnt vmcnt(4)
  v_add_u32 v20, 1, v20
  ds_write_b32 v21, v20
  s_waitcnt vmcnt(3)
  v_add_u32 v20, 1, v20
  ds_write_b32 v21, v20
  s_waitcnt vmcnt(2)
  v_add_u32 v20, 1, v20
  ds_write_b32 v21, v20
  s_waitcnt vmcnt(1)
  v_add_u32 v20, 1, v20
  ds_write_b32 v21, v20
  s_waitcnt vmcnt(0)
  v_add_u32 v20, 1, v20
  ds_write_b32 v21, v20
  s_branch L_ldEnd
L_ldEnd:
  s_branch L_fin
L_compute:
  s_sub_u32 s49, s3, 1
  s_mov_b32 s47, -1000
  v_and_b32 v2, 15, v1
  v_lshrrev_b32 v3, 4, v1
  v_mov_b32 v5, 1
  s_mov_b32 s60, 0x07060501
  s_mov_b32 s61, 0x07060502
  s_mov_b32 s62, 0x07060503
  s_mov_b32 s63, 0x04000c0c
  s_mov_b32 s64, 0x0706000c
  v_lshlrev_b32 v14, 5, v1
  v_min_u32 v15, 35, v1
  s_mul_i32 s51, s49, 36
  v_add_u32 v15, s51, v15
  v_lshlrev_b32 v18, 3, v15
  s_mul_i32 s52, s28, 5
  s_add_u32 s52, s52, s29
  s_sub_u32 s52, s52, 27
  s_lshl_b32 s53, s52, 5
  v_and_b32 v19, 3, v1
  v_lshl_add_u32 v19, v19, 3, s53
  s_cmp_ge_u32 s29, 27
  s_cselect_b64 s[56:57], -1, 0
  v_cndmask_b32 v18, v18, v19, s[56:57]
  s_waitcnt lgkmcnt(0)
  s_mov_b32 s36, s4
  s_mov_b32 s37, s5
  s_mov_b32 s38, 1152
  s_mov_b32 s39, 0x20000
  buffer_load_dwordx4 v[20:23], v14, s[36:39], 0 offen
  buffer_load_dwordx4 v[24:27], v14, s[36:39], 0 offen offset:16
  buffer_load_dwordx2 v[16:17], v18, s[36:39], 0 offen
  s_load_dword s48, s[26:27], 0
  s_mov_b32 s71, 0
  s_barrier
  s_mov_b32 s32, s26
  s_mov_b32 s33, s27
  s_mov_b32 s34, 1048576
  s_mov_b32 s35, 0x20000
  s_mov_b32 s40, s22
  s_mov_b32 s41, s23
  s_mov_b32 s42, 1152
  s_mov_b32 s43, 0x20000
  v_lshrrev_b32 v28, 2, v2
  v_and_b32 v29, 3, v2
  v_and_b32 v30, 1, v3
  v_lshrrev_b32 v31, 1, v3
  v_lshl_add_u32 v32, v30, 2, v28
  v_lshrrev_b32 v33, 1, v32
  v_xor_b32 v33, s49, v33
  v_lshlrev_b32 v33, 5, v33
  v_lshl_add_u32 v33, v29, 3, v33
  v_lshl_add_u32 v33, v32, 7, v33
  v_lshl_add_u32 v7, v31, 10, v33
  v_lshl_add_u32 v33, v3, 2, v28
  s_lshl_b32 s51, s49, 1
  v_xor_b32 v34, s51, v32
  v_lshlrev_b32 v34, 5, v34
  v_lshl_add_u32 v34, v29, 3, v34
  v_lshl_add_u32 v34, v33, 8, v34
  v_add_u32 v8, 83968, v34
  v_xor_b32 v34, 32, v34
  v_add_u32 v9, 83968, v34
  v_xor_b32 v33, v3, v2
  v_lshlrev_b32 v33, 4, v33
  v_lshl_add_u32 v33, v2, 8, v33
  s_lshl_b32 s51, s49, 14
  s_add_u32 s51, s51, 18432
  v_add_u32 v10, s51, v33
  v_xor_b32 v34, 64, v33
  v_add_u32 v11, s51, v34
  v_xor_b32 v34, 128, v33
  v_add_u32 v12, s51, v34
  v_xor_b32 v34, 192, v33
  v_add_u32 v13, s51, v34
  v_add_u32 v50, 512, v14
  v_add_u32 v50, v50, v4
  s_lshr_b32 s51, s31, 2
  s_mul_i32 s51, s51, 288
  s_add_u32 s51, s51, 150016
  v_lshl_add_u32 v51, v3, 3, s51
  v_and_b32 v33, 1, v2
  v_lshlrev_b32 v34, 8, v33
  v_lshl_add_u32 v34, v3, 4, v34
  v_add_u32 v52, v34, v4
  v_lshl_add_u32 v53, v33, 4, v4
  s_lshl_b32 s51, s49, 2
  v_add_u32 v54, s51, v53
  v_lshl_add_u32 v55, v3, 5, v53
  s_lshl_b32 s51, s49, 8
  v_add_u32 v56, s51, v55
  s_lshl_b32 s65, s30, 2
  s_lshr_b32 s52, s31, 2
  s_add_u32 s65, s65, s52
  s_lshl_b32 s65, s65, 10
  s_and_b32 s52, s31, 3
  s_lshl_b32 s52, s52, 8
  s_add_u32 s65, s65, s52
  s_lshl_b32 s52, s49, 6
  s_add_u32 s65, s65, s52
  s_add_u32 s65, s65, 4096
  v_lshlrev_b32 v57, 4, v3
  s_lshl_b32 s66, s30, 14
  s_lshl_b32 s52, s31, 9
  s_add_u32 s66, s66, s52
  s_lshl_b32 s52, s49, 7
  s_add_u32 s66, s66, s52
  s_add_u32 s66, s66, 131072
  v_and_b32 v58, 1, v2
  v_lshlrev_b32 v58, 13, v58
  v_bfe_u32 v33, v2, 1, 1
  v_lshl_add_u32 v58, v33, 6, v58
  v_lshl_add_u32 v58, v3, 4, v58
  s_lshl_b32 s67, s30, 12
  s_lshl_b32 s52, s31, 7
  s_add_u32 s67, s67, s52
  s_add_u32 s67, s67, 393216
  v_and_b32 v59, 1, v2
  v_lshlrev_b32 v59, 11, v59
  v_lshrrev_b32 v33, 1, v2
  v_lshl_add_u32 v59, v33, 4, v59
  s_lshl_b32 s68, s30, 12
  s_add_u32 s68, s68, 4096
  s_lshl_b32 s69, s49, 4
  s_add_u32 s69, s69, 34
  v_mov_b32 v44, 0
  v_mov_b32 v45, 0
  s_waitcnt lgkmcnt(0)
  s_add_u32 s48, s48, 2654435769
  v_mov_b32 v6, s48
  s_getreg_b32 s44, hwreg(HW_REG_XCC_ID, 0, 4)
  s_lshl_b32 s51, s28, 12
  s_add_u32 s70, s51, 983040
  v_and_b32 v232, 31, v1
  v_lshlrev_b32 v232, 7, v232
  v_mov_b32 v89, 0
  s_cmp_eq_u32 s49, 2
  s_cbranch_scc0 L_nox
  s_lshl_b32 s51, s29, 7
  s_add_u32 s51, s51, s70
  v_mov_b32 v60, s44
  v_mov_b32 v61, 0
  v_mov_b32 v62, 0
  v_mov_b32 v63, v6
  s_mov_b64 exec, 1
  buffer_store_dwordx4 v[60:63], v89, s[32:35], s51 offen sc1
  s_mov_b64 exec, -1
  s_waitcnt vmcnt(1)
  s_branch L_xw1
L_nox:
  s_cmp_eq_u32 s71, 0
  s_cbranch_scc1 L_xw0
  s_waitcnt vmcnt(CODE_KB)
  s_branch L_xw1
L_xw0:
  s_waitcnt vmcnt(0)
L_xw1:
  s_cmp_eq_u32 s49, 1
  s_cbranch_scc0 L_nopt
  v_lshlrev_b32 v33, 6, v1
  buffer_load_dword v244, v33, s[32:35], s68 offen sc1
L_nopt:
  v_lshlrev_b32 v28, 16, v20
  v_and_b32 v29, 0xffff0000, v20
  v_readfirstlane_b32 s52, v28
  v_lshlrev_b32 v30, 16, v21
  v_and_b32 v31, 0xffff0000, v21
  v_lshlrev_b32 v32, 16, v22
  v_and_b32 v33, 0xffff0000, v22
  v_lshlrev_b32 v34, 16, v23
  v_and_b32 v35, 0xffff0000, v23
  v_lshlrev_b32 v36, 16, v24
  v_and_b32 v37, 0xffff0000, v24
  v_lshlrev_b32 v38, 16, v25
  v_and_b32 v39, 0xffff0000, v25
  v_lshlrev_b32 v40, 16, v26
  v_and_b32 v41, 0xffff0000, v26
  v_lshlrev_b32 v42, 16, v27
  v_and_b32 v43, 0xffff0000, v27
  s_mov_b32 exec_hi, 15
  v_pk_add_f32 v[64:65], v[28:29], s[52:53] op_sel_hi:[1,0] neg_lo:[0,1] neg_hi:[0,1]
  v_pk_add_f32 v[66:67], v[30:31], s[52:53] op_sel_hi:[1,0] neg_lo:[0,1] neg_hi:[0,1]
  v_pk_add_f32 v[68:69], v[32:33], s[52:53] op_sel_hi:[1,0] neg_lo:[0,1] neg_hi:[0,1]
  v_pk_add_f32 v[70:71], v[34:35], s[52:53] op_sel_hi:[1,0] neg_lo:[0,1] neg_hi:[0,1]
  v_pk_add_f32 v[72:73], v[36:37], s[52:53] op_sel_hi:[1,0] neg_lo:[0,1] neg_hi:[0,1]
  v_pk_add_f32 v[74:75], v[38:39], s[52:53] op_sel_hi:[1,0] neg_lo:[0,1] neg_hi:[0,1]
  v_pk_add_f32 v[76:77], v[40:41], s[52:53] op_sel_hi:[1,0] neg_lo:[0,1] neg_hi:[0,1]
  v_pk_add_f32 v[78:79], v[42:43], s[52:53] op_sel_hi:[1,0] neg_lo:[0,1] neg_hi:[0,1]
  v_pk_mul_f32 v[46:47], v[64:65], v[64:65]
  v_pk_fma_f32 v[46:47], v[66:67], v[66:67], v[46:47]
  v_pk_fma_f32 v[46:47], v[68:69], v[68:69], v[46:47]
  v_pk_fma_f32 v[46:47], v[70:71], v[70:71], v[46:47]
  v_pk_fma_f32 v[46:47], v[72:73], v[72:73], v[46:47]
  v_pk_fma_f32 v[46:47], v[74:75], v[74:75], v[46:47]
  v_pk_fma_f32 v[46:47], v[76:77], v[76:77], v[46:47]
  v_pk_fma_f32 v[46:47], v[78:79], v[78:79], v[46:47]
  v_pk_add_f32 v[64:65], v[64:65], v[72:73]
  v_pk_add_f32 v[66:67], v[66:67], v[74:75]
  v_pk_add_f32 v[68:69], v[68:69], v[76:77]
  v_pk_add_f32 v[70:71], v[70:71], v[78:79]
  v_pk_add_f32 v[64:65], v[64:65], v[66:67]
  v_pk_add_f32 v[68:69], v[68:69], v[70:71]
  v_pk_add_f32 v[64:65], v[64:65], v[68:69]
  v_add_f32 v44, v64, v65
  v_add_f32 v45, v46, v47
  s_mov_b64 exec, -1
  v_add_f32_dpp v44, v44, v44 row_ror:8 row_mask:0xf bank_mask:0xf
  v_add_f32_dpp v45, v45, v45 row_ror:8 row_mask:0xf bank_mask:0xf
  s_nop 0
  v_add_f32_dpp v44, v44, v44 row_ror:4 row_mask:0xf bank_mask:0xf
  v_add_f32_dpp v45, v45, v45 row_ror:4 row_mask:0xf bank_mask:0xf
  s_nop 0
  v_add_f32_dpp v44, v44, v44 row_ror:2 row_mask:0xf bank_mask:0xf
  v_add_f32_dpp v45, v45, v45 row_ror:2 row_mask:0xf bank_mask:0xf
  s_nop 0
  v_add_f32_dpp v44, v44, v44 row_ror:1 row_mask:0xf bank_mask:0xf
  v_add_f32_dpp v45, v45, v45 row_ror:1 row_mask:0xf bank_mask:0xf
  v_mov_b32 v46, v44
  v_mov_b32 v47, v45
  s_nop 0
  v_permlane16_swap_b32 v44, v46
  v_permlane16_swap_b32 v45, v47
  v_add_f32 v44, v44, v46
  v_add_f32 v45, v45, v47
  v_mov_b32 v46, v44
  v_mov_b32 v47, v45
  s_nop 0
  v_permlane32_swap_b32 v44, v46
  v_permlane32_swap_b32 v45, v47
  v_add_f32 v44, v44, v46
  v_add_f32 v45, v45, v47
  v_mul_f32 v44, 0x3ae38e39, v44
  v_mul_f32 v45, 0x3ae38e39, v45
  v_fma_f32 v45, -v44, v44, v45
  v_add_f32 v44, s52, v44
  v_max_f32 v45, 0, v45
  v_cvt_pk_bf16_f32 v46, v45, v44
  v_lshlrev_b32 v45, 16, v46
  v_and_b32 v44, 0xffff0000, v46
  v_add_f32 v45, 0x3727c5ac, v45
  v_cvt_pk_bf16_f32 v46, v45, v45
  v_lshlrev_b32 v45, 16, v46
  v_sqrt_f32 v45, v45
  s_nop 0
  v_cvt_pk_bf16_f32 v46, v45, v45
  v_lshlrev_b32 v45, 16, v46
  v_rcp_f32 v45, v45
  s_nop 0
  v_pk_add_f32 v[28:29], v[28:29], v[44:45] op_sel_hi:[1,0] neg_lo:[0,1] neg_hi:[0,1]
  v_pk_add_f32 v[30:31], v[30:31], v[44:45] op_sel_hi:[1,0] neg_lo:[0,1] neg_hi:[0,1]
  v_pk_add_f32 v[32:33], v[32:33], v[44:45] op_sel_hi:[1,0] neg_lo:[0,1] neg_hi:[0,1]
  v_pk_add_f32 v[34:35], v[34:35], v[44:45] op_sel_hi:[1,0] neg_lo:[0,1] neg_hi:[0,1]
  v_pk_add_f32 v[36:37], v[36:37], v[44:45] op_sel_hi:[1,0] neg_lo:[0,1] neg_hi:[0,1]
  v_pk_add_f32 v[38:39], v[38:39], v[44:45] op_sel_hi:[1,0] neg_lo:[0,1] neg_hi:[0,1]
  v_pk_add_f32 v[40:41], v[40:41], v[44:45] op_sel_hi:[1,0] neg_lo:[0,1] neg_hi:[0,1]
  v_pk_add_f32 v[42:43], v[42:43], v[44:45] op_sel_hi:[1,0] neg_lo:[0,1] neg_hi:[0,1]
  v_cvt_pk_bf16_f32 v20, v28, v29
  v_cvt_pk_bf16_f32 v21, v30, v31
  v_cvt_pk_bf16_f32 v22, v32, v33
  v_cvt_pk_bf16_f32 v23, v34, v35
  v_cvt_pk_bf16_f32 v24, v36, v37
  v_cvt_pk_bf16_f32 v25, v38, v39
  v_cvt_pk_bf16_f32 v26, v40, v41
  v_cvt_pk_bf16_f32 v27, v42, v43
  v_lshlrev_b32 v28, 16, v20
  v_and_b32 v29, 0xffff0000, v20
  v_lshlrev_b32 v30, 16, v21
  v_and_b32 v31, 0xffff0000, v21
  v_lshlrev_b32 v32, 16, v22
  v_and_b32 v33, 0xffff0000, v22
  v_lshlrev_b32 v34, 16, v23
  v_and_b32 v35, 0xffff0000, v23
  v_lshlrev_b32 v36, 16, v24
  v_and_b32 v37, 0xffff0000, v24
  v_lshlrev_b32 v38, 16, v25
  v_and_b32 v39, 0xffff0000, v25
  v_lshlrev_b32 v40, 16, v26
  v_and_b32 v41, 0xffff0000, v26
  v_lshlrev_b32 v42, 16, v27
  v_and_b32 v43, 0xffff0000, v27
  v_pk_mul_f32 v[28:29], v[28:29], v[44:45] op_sel:[0,1] op_sel_hi:[1,1]
  v_pk_mul_f32 v[30:31], v[30:31], v[44:45] op_sel:[0,1] op_sel_hi:[1,1]
  v_pk_mul_f32 v[32:33], v[32:33], v[44:45] op_sel:[0,1] op_sel_hi:[1,1]
  v_pk_mul_f32 v[34:35], v[34:35], v[44:45] op_sel:[0,1] op_sel_hi:[1,1]
  v_pk_mul_f32 v[36:37], v[36:37], v[44:45] op_sel:[0,1] op_sel_hi:[1,1]
  v_pk_mul_f32 v[38:39], v[38:39], v[44:45] op_sel:[0,1] op_sel_hi:[1,1]
  v_pk_mul_f32 v[40:41], v[40:41], v[44:45] op_sel:[0,1] op_sel_hi:[1,1]
  v_pk_mul_f32 v[42:43], v[42:43], v[44:45] op_sel:[0,1] op_sel_hi:[1,1]
  v_cvt_pk_bf16_f32 v20, v28, v29
  v_cvt_pk_bf16_f32 v21, v30, v31
  v_cvt_pk_bf16_f32 v22, v32, v33
  v_cvt_pk_bf16_f32 v23, v34, v35
  v_cvt_pk_bf16_f32 v24, v36, v37
  v_cvt_pk_bf16_f32 v25, v38, v39
  v_cvt_pk_bf16_f32 v26, v40, v41
  v_cvt_pk_bf16_f32 v27, v42, v43
  s_mov_b32 exec_hi, 15
  ds_write_b128 v50, v[20:23]
  ds_write_b128 v50, v[24:27] offset:16
  s_mov_b64 exec, -1
  v_mov_b32 v60, 0
  v_mov_b32 v61, 0
  v_mov_b32 v62, 0
  v_mov_b32 v63, 0
  s_cmp_ge_i32 s47, 18
  s_cbranch_scc1 Lw_13d
Lw_13:
  ds_read_b32 v15, v4 offset:0
  s_waitcnt lgkmcnt(0)
  v_readfirstlane_b32 s47, v15
  s_nop 0
  s_cmp_ge_i32 s47, 18
  s_cbranch_scc1 Lw_13d
  s_sub_u32 s50, s50, 1
  s_cbranch_scc0 Lw_13
  s_mov_b32 s50, 0
Lw_13d:
  ds_read_b64 v[20:21], v51 offset:0
  ds_read_b64_tr_b16 v[64:65], v7 offset:0
  ds_read_b64 v[22:23], v51 offset:32
  ds_read_b64_tr_b16 v[66:67], v7 offset:2048
  ds_read_b64 v[24:25], v51 offset:64
  ds_read_b64_tr_b16 v[68:69], v7 offset:4096
  ds_read_b64 v[26:27], v51 offset:96
  ds_read_b64_tr_b16 v[70:71], v7 offset:6144
  ds_read_b64 v[28:29], v51 offset:128
  ds_read_b64_tr_b16 v[72:73], v7 offset:8192
  ds_read_b64 v[30:31], v51 offset:160
  ds_read_b64_tr_b16 v[74:75], v7 offset:10240
  ds_read_b64 v[32:33], v51 offset:192
  ds_read_b64_tr_b16 v[76:77], v7 offset:12288
  ds_read_b64 v[34:35], v51 offset:224
  ds_read_b64_tr_b16 v[78:79], v7 offset:14336
  ds_read_b64 v[36:37], v51 offset:256
  ds_read_b64_tr_b16 v[80:81], v7 offset:16384
  s_waitcnt lgkmcnt(12)
  v_mfma_f32_16x16x16_bf16 v[60:63], v[64:65], v[20:21], v[60:63]
  v_mfma_f32_16x16x16_bf16 v[60:63], v[66:67], v[22:23], v[60:63]
  v_mfma_f32_16x16x16_bf16 v[60:63], v[68:69], v[24:25], v[60:63]
  s_waitcnt lgkmcnt(6)
  v_mfma_f32_16x16x16_bf16 v[60:63], v[70:71], v[26:27], v[60:63]
  v_mfma_f32_16x16x16_bf16 v[60:63], v[72:73], v[28:29], v[60:63]
  v_mfma_f32_16x16x16_bf16 v[60:63], v[74:75], v[30:31], v[60:63]
  s_waitcnt lgkmcnt(0)
  v_mfma_f32_16x16x16_bf16 v[60:63], v[76:77], v[32:33], v[60:63]
  v_mfma_f32_16x16x16_bf16 v[60:63], v[78:79], v[34:35], v[60:63]
  v_mfma_f32_16x16x16_bf16 v[60:63], v[80:81], v[36:37], v[60:63]
  s_nop 7
  v_perm_b32 v224, v60, v61, s60
  v_perm_b32 v225, v62, v61, s61
  v_perm_b32 v226, v63, v61, s62
  v_mov_b32 v227, v6
  s_mov_b32 exec_lo, 0x00010001
  s_mov_b32 exec_hi, 0x00010001
  buffer_store_dwordx4 v[224:227], v57, s[32:35], s65 offen
  s_mov_b64 exec, -1
  s_mov_b32 s45, 0
  s_cmp_eq_u32 s49, 2
  s_cbranch_scc0 L_nox2
  buffer_load_dwordx4 v[228:231], v232, s[32:35], s70 offen sc1
L_nox2:
  s_cmp_ge_i32 s47, s69
  s_cbranch_scc1 Lw_14d
Lw_14:
  ds_read_b32 v15, v4 offset:0
  s_waitcnt lgkmcnt(0)
  v_readfirstlane_b32 s47, v15
  s_nop 0
  s_cmp_ge_i32 s47, s69
  s_cbranch_scc1 Lw_14d
  s_sub_u32 s50, s50, 1
  s_cbranch_scc0 Lw_14
  s_mov_b32 s50, 0
Lw_14d:
  ds_read_b128 v[64:67], v10 offset:0
  ds_read_b128 v[68:71], v11 offset:0
  ds_read_b128 v[72:75], v12 offset:0
  ds_read_b128 v[76:79], v13 offset:0
  ds_read_b128 v[80:83], v10 offset:4096
  ds_read_b128 v[84:87], v11 offset:4096
  ds_read_b128 v[88:91], v12 offset:4096
  ds_read_b128 v[92:95], v13 offset:4096
  ds_read_b128 v[96:99], v10 offset:8192
  ds_read_b128 v[100:103], v11 offset:8192
  ds_read_b128 v[104:107], v12 offset:8192
  ds_read_b128 v[108:111], v13 offset:8192
  ds_read_b128 v[112:115], v10 offset:12288
  ds_read_b128 v[116:119], v11 offset:12288
  ds_read_b128 v[120:123], v12 offset:12288
  ds_read_b128 v[124:127], v13 offset:12288
  s_waitcnt lgkmcnt(0)
  s_mov_b64 exec, 1
  ds_add_u32 v4, v5 offset:256
  s_mov_b64 exec, -1
  s_cmp_eq_u32 s49, 2
  s_cbranch_scc0 L_nox3
Lx_15:
  s_waitcnt vmcnt(0)
  v_cmp_ne_u32 vcc, v231, v6
  s_cbranch_vccz Lx_15d
  buffer_load_dwordx4 v[228:231], v232, s[32:35], s70 offen sc1
  s_sub_u32 s50, s50, 1
  s_cbranch_scc0 Lx_15
  s_mov_b32 s50, 0
Lx_15d:
  v_cmp_ne_u32 vcc, s44, v228
  v_cmp_ne_u32 s[56:57], v231, v6
  s_nop 0
  s_or_b64 vcc, vcc, s[56:57]
  s_cmp_eq_u64 vcc, 0
  s_cselect_b32 s51, 1, 2
  v_mov_b32 v228, s51
  s_mov_b64 exec, 1
  ds_write_b32 v4, v228 offset:268
  s_mov_b64 exec, -1
L_nox3:
  s_cmp_eq_u32 s49, 0
  s_cbranch_scc0 L_noq
  v_lshlrev_b32 v14, 4, v1
  v_lshlrev_b32 v19, 3, v1
  v_add_u32 v19, v19, v4
Lg_16:
  buffer_load_dwordx4 v[20:23], v14, s[32:35], s68 offen offset:0 sc1
  buffer_load_dwordx4 v[24:27], v14, s[32:35], s68 offen offset:1024 sc1
  buffer_load_dwordx4 v[28:31], v14, s[32:35], s68 offen offset:2048 sc1
  buffer_load_dwordx4 v[32:35], v14, s[32:35], s68 offen offset:3072 sc1
  ds_read_b32 v37, v4 offset:268
  s_waitcnt vmcnt(0) lgkmcnt(0)
  v_xor_b32 v36, v23, v6
  v_bitop3_b32 v36, v27, v6, v36 bitop3:0xbe
  v_bitop3_b32 v36, v31, v6, v36 bitop3:0xbe
  v_bitop3_b32 v36, v35, v6, v36 bitop3:0xbe
  v_cmp_ne_u32 vcc, 0, v36
  s_cbranch_vccz Lg_16d
  v_readfirstlane_b32 s52, v37
  s_cmp_lg_u32 s45, 0
  s_cbranch_scc1 Lc_17
  s_mov_b32 s45, s52
  s_cmp_eq_u32 s52, 2
  s_cbranch_scc0 Lc_17
  s_mov_b32 exec_lo, 0x00010001
  s_mov_b32 exec_hi, 0x00010001
  buffer_store_dwordx4 v[224:227], v57, s[32:35], s65 offen sc1
  s_mov_b64 exec, -1
Lc_17:
  s_sub_u32 s50, s50, 1
  s_cbranch_scc0 Lg_16
  s_mov_b32 s50, 0
Lg_16d:
  v_perm_b32 v40, v22, v21, s63
  v_perm_b32 v40, v40, v20, s64
  v_perm_b32 v41, v26, v25, s63
  v_perm_b32 v41, v41, v24, s64
  v_perm_b32 v42, v30, v29, s63
  v_perm_b32 v42, v42, v28, s64
  v_perm_b32 v43, v34, v33, s63
  v_perm_b32 v43, v43, v32, s64
  v_pk_add_f32 v[20:21], v[20:21], v[24:25]
  v_pk_add_f32 v[28:29], v[28:29], v[32:33]
  v_pk_add_f32 v[20:21], v[20:21], v[28:29]
  v_pk_add_f32 v[40:41], v[40:41], v[42:43]
  v_add_f32 v40, v40, v41
  v_add_f32 v22, v22, v26
  v_add_f32 v30, v30, v34
  v_add_f32 v22, v22, v30
  v_cvt_pk_bf16_f32 v48, v20, v40
  v_cvt_pk_bf16_f32 v49, v21, v22
  ds_write_b64 v19, v[48:49] offset:1664
  s_mov_b64 exec, 1
  ds_add_u32 v4, v5 offset:264
  s_mov_b64 exec, -1
L_noq:
Lq_18:
  ds_read_b64 v[36:37], v4 offset:264
  s_waitcnt lgkmcnt(0)
  v_readfirstlane_b32 s52, v37
  s_cmp_lg_u32 s45, 0
  s_cbranch_scc1 Lc_19
  s_mov_b32 s45, s52
  s_cmp_eq_u32 s52, 2
  s_cbranch_scc0 Lc_19
  s_mov_b32 exec_lo, 0x00010001
  s_mov_b32 exec_hi, 0x00010001
  buffer_store_dwordx4 v[224:227], v57, s[32:35], s65 offen sc1
  s_mov_b64 exec, -1
Lc_19:
  v_readfirstlane_b32 s51, v36
  s_nop 0
  s_cmp_ge_i32 s51, 1
  s_cbranch_scc1 Lq_18d
  s_sub_u32 s50, s50, 1
  s_cbranch_scc0 Lq_18
  s_mov_b32 s50, 0
Lq_18d:
  v_mov_b32 v144, 0
  v_mov_b32 v145, 0
  v_mov_b32 v146, 0
  v_mov_b32 v147, 0
  v_mov_b32 v148, 0
  v_mov_b32 v149, 0
  v_mov_b32 v150, 0
  v_mov_b32 v151, 0
  v_mov_b32 v152, 0
  v_mov_b32 v153, 0
  v_mov_b32 v154, 0
  v_mov_b32 v155, 0
  v_mov_b32 v156, 0
  v_mov_b32 v157, 0
  v_mov_b32 v158, 0
  v_mov_b32 v159, 0
  ds_read_b128 v[128:131], v52 offset:1664
  ds_read_b128 v[132:135], v52 offset:1728
  ds_read_b128 v[136:139], v52 offset:1792
  ds_read_b128 v[140:143], v52 offset:1856
  s_mov_b32 s52, 0x3db504f3
  s_mov_b32 s54, 0x3fb8aa3b
  s_waitcnt lgkmcnt(3)
  v_mfma_f32_16x16x32_bf16 v[144:147], v[64:67], v[128:131], v[144:147]
  v_mfma_f32_16x16x32_bf16 v[148:151], v[80:83], v[128:131], v[148:151]
  v_mfma_f32_16x16x32_bf16 v[152:155], v[96:99], v[128:131], v[152:155]
  v_mfma_f32_16x16x32_bf16 v[156:159], v[112:115], v[128:131], v[156:159]
  s_waitcnt lgkmcnt(2)
  v_mfma_f32_16x16x32_bf16 v[144:147], v[68:71], v[132:135], v[144:147]
  v_mfma_f32_16x16x32_bf16 v[148:151], v[84:87], v[132:135], v[148:151]
  v_mfma_f32_16x16x32_bf16 v[152:155], v[100:103], v[132:135], v[152:155]
  v_mfma_f32_16x16x32_bf16 v[156:159], v[116:119], v[132:135], v[156:159]
  s_waitcnt lgkmcnt(1)
  v_mfma_f32_16x16x32_bf16 v[144:147], v[72:75], v[136:139], v[144:147]
  v_mfma_f32_16x16x32_bf16 v[148:151], v[88:91], v[136:139], v[148:151]
  v_mfma_f32_16x16x32_bf16 v[152:155], v[104:107], v[136:139], v[152:155]
  v_mfma_f32_16x16x32_bf16 v[156:159], v[120:123], v[136:139], v[156:159]
  s_waitcnt lgkmcnt(0)
  v_mfma_f32_16x16x32_bf16 v[144:147], v[76:79], v[140:143], v[144:147]
  v_mfma_f32_16x16x32_bf16 v[148:151], v[92:95], v[140:143], v[148:151]
  v_mfma_f32_16x16x32_bf16 v[152:155], v[108:111], v[140:143], v[152:155]
  v_mfma_f32_16x16x32_bf16 v[156:159], v[124:127], v[140:143], v[156:159]
  s_nop 4
  v_cvt_pk_bf16_f32 v20, v144, v145
  v_cvt_pk_bf16_f32 v21, v146, v147
  v_cvt_pk_bf16_f32 v22, v148, v149
  v_cvt_pk_bf16_f32 v23, v150, v151
  v_cvt_pk_bf16_f32 v24, v152, v153
  v_cvt_pk_bf16_f32 v25, v154, v155
  v_cvt_pk_bf16_f32 v26, v156, v157
  v_cvt_pk_bf16_f32 v27, v158, v159
  v_lshlrev_b32 v144, 16, v20
  v_and_b32 v145, 0xffff0000, v20
  v_lshlrev_b32 v146, 16, v21
  v_and_b32 v147, 0xffff0000, v21
  v_lshlrev_b32 v148, 16, v22
  v_and_b32 v149, 0xffff0000, v22
  v_lshlrev_b32 v150, 16, v23
  v_and_b32 v151, 0xffff0000, v23
  v_lshlrev_b32 v152, 16, v24
  v_and_b32 v153, 0xffff0000, v24
  v_lshlrev_b32 v154, 16, v25
  v_and_b32 v155, 0xffff0000, v25
  v_lshlrev_b32 v156, 16, v26
  v_and_b32 v157, 0xffff0000, v26
  v_lshlrev_b32 v158, 16, v27
  v_and_b32 v159, 0xffff0000, v27
  v_pk_mul_f32 v[144:145], v[144:145], s[52:53] op_sel_hi:[1,0]
  v_pk_mul_f32 v[146:147], v[146:147], s[52:53] op_sel_hi:[1,0]
  v_pk_mul_f32 v[148:149], v[148:149], s[52:53] op_sel_hi:[1,0]
  v_pk_mul_f32 v[150:151], v[150:151], s[52:53] op_sel_hi:[1,0]
  v_pk_mul_f32 v[152:153], v[152:153], s[52:53] op_sel_hi:[1,0]
  v_pk_mul_f32 v[154:155], v[154:155], s[52:53] op_sel_hi:[1,0]
  v_pk_mul_f32 v[156:157], v[156:157], s[52:53] op_sel_hi:[1,0]
  v_pk_mul_f32 v[158:159], v[158:159], s[52:53] op_sel_hi:[1,0]
  v_cvt_pk_bf16_f32 v20, v144, v145
  v_cvt_pk_bf16_f32 v21, v146, v147
  v_cvt_pk_bf16_f32 v22, v148, v149
  v_cvt_pk_bf16_f32 v23, v150, v151
  v_cvt_pk_bf16_f32 v24, v152, v153
  v_cvt_pk_bf16_f32 v25, v154, v155
  v_cvt_pk_bf16_f32 v26, v156, v157
  v_cvt_pk_bf16_f32 v27, v158, v159
  v_lshlrev_b32 v144, 16, v20
  v_and_b32 v145, 0xffff0000, v20
  v_lshlrev_b32 v146, 16, v21
  v_and_b32 v147, 0xffff0000, v21
  v_lshlrev_b32 v148, 16, v22
  v_and_b32 v149, 0xffff0000, v22
  v_lshlrev_b32 v150, 16, v23
  v_and_b32 v151, 0xffff0000, v23
  v_lshlrev_b32 v152, 16, v24
  v_and_b32 v153, 0xffff0000, v24
  v_lshlrev_b32 v154, 16, v25
  v_and_b32 v155, 0xffff0000, v25
  v_lshlrev_b32 v156, 16, v26
  v_and_b32 v157, 0xffff0000, v26
  v_lshlrev_b32 v158, 16, v27
  v_and_b32 v159, 0xffff0000, v27
  v_max3_f32 v20, v144, v145, v146
  v_max3_f32 v20, v20, v147, v148
  v_max3_f32 v20, v20, v149, v150
  v_max3_f32 v20, v20, v151, v152
  v_max3_f32 v20, v20, v153, v154
  v_max3_f32 v20, v20, v155, v156
  v_max3_f32 v20, v20, v157, v158
  v_max_f32 v20, v20, v159
  v_mov_b32 v21, v20
  s_nop 1
  v_permlane16_swap_b32 v20, v21
  v_max_f32 v20, v20, v21
  v_mov_b32 v21, v20
  s_nop 1
  v_permlane32_swap_b32 v20, v21
  v_max_f32 v20, v20, v21
  s_mov_b64 exec, 3
  ds_write_b32 v54, v20 offset:2176
  s_mov_b64 exec, 1
  ds_add_u32 v4, v5 offset:272
  s_mov_b64 exec, -1
Lw_20:
  ds_read_b32 v15, v4 offset:272
  s_waitcnt lgkmcnt(0)
  v_readfirstlane_b32 s51, v15
  s_nop 0
  s_cmp_ge_i32 s51, 4
  s_cbranch_scc1 Lw_20d
  s_sub_u32 s50, s50, 1
  s_cbranch_scc0 Lw_20
  s_mov_b32 s50, 0
Lw_20d:
  ds_read_b128 v[24:27], v53 offset:2176
  s_waitcnt lgkmcnt(0)
  v_max3_f32 v23, v24, v25, v26
  v_max_f32 v22, v23, v27
  v_max_f32 v23, v23, v27
  v_pk_add_f32 v[144:145], v[144:145], v[22:23] neg_lo:[0,1] neg_hi:[0,1]
  v_pk_add_f32 v[146:147], v[146:147], v[22:23] neg_lo:[0,1] neg_hi:[0,1]
  v_pk_add_f32 v[148:149], v[148:149], v[22:23] neg_lo:[0,1] neg_hi:[0,1]
  v_pk_add_f32 v[150:151], v[150:151], v[22:23] neg_lo:[0,1] neg_hi:[0,1]
  v_pk_add_f32 v[152:153], v[152:153], v[22:23] neg_lo:[0,1] neg_hi:[0,1]
  v_pk_add_f32 v[154:155], v[154:155], v[22:23] neg_lo:[0,1] neg_hi:[0,1]
  v_pk_add_f32 v[156:157], v[156:157], v[22:23] neg_lo:[0,1] neg_hi:[0,1]
  v_pk_add_f32 v[158:159], v[158:159], v[22:23] neg_lo:[0,1] neg_hi:[0,1]
  v_pk_mul_f32 v[144:145], v[144:145], s[54:55] op_sel_hi:[1,0]
  v_pk_mul_f32 v[146:147], v[146:147], s[54:55] op_sel_hi:[1,0]
  v_pk_mul_f32 v[148:149], v[148:149], s[54:55] op_sel_hi:[1,0]
  v_pk_mul_f32 v[150:151], v[150:151], s[54:55] op_sel_hi:[1,0]
  v_pk_mul_f32 v[152:153], v[152:153], s[54:55] op_sel_hi:[1,0]
  v_pk_mul_f32 v[154:155], v[154:155], s[54:55] op_sel_hi:[1,0]
  v_pk_mul_f32 v[156:157], v[156:157], s[54:55] op_sel_hi:[1,0]
  v_pk_mul_f32 v[158:159], v[158:159], s[54:55] op_sel_hi:[1,0]
  v_exp_f32 v144, v144
  v_exp_f32 v145, v145
  v_exp_f32 v146, v146
  v_exp_f32 v147, v147
  v_exp_f32 v148, v148
  v_exp_f32 v149, v149
  v_exp_f32 v150, v150
  v_exp_f32 v151, v151
  v_exp_f32 v152, v152
  v_exp_f32 v153, v153
  v_exp_f32 v154, v154
  v_exp_f32 v155, v155
  v_exp_f32 v156, v156
  v_exp_f32 v157, v157
  v_exp_f32 v158, v158
  v_exp_f32 v159, v159
  v_cvt_pk_bf16_f32 v24, v144, v145
  v_cvt_pk_bf16_f32 v25, v146, v147
  v_cvt_pk_bf16_f32 v26, v148, v149
  v_cvt_pk_bf16_f32 v27, v150, v151
  v_cvt_pk_bf16_f32 v28, v152, v153
  v_cvt_pk_bf16_f32 v29, v154, v155
  v_cvt_pk_bf16_f32 v30, v156, v157
  v_cvt_pk_bf16_f32 v31, v158, v159
  s_mov_b32 exec_lo, 0x00030003
  s_mov_b32 exec_hi, 0x00030003
  ds_write_b128 v56, v[24:27] offset:2304
  ds_write_b128 v56, v[28:31] offset:2432
  s_mov_b64 exec, -1
  v_pk_add_f32 v[144:145], v[144:145], v[152:153]
  v_pk_add_f32 v[146:147], v[146:147], v[154:155]
  v_pk_add_f32 v[148:149], v[148:149], v[156:157]
  v_pk_add_f32 v[150:151], v[150:151], v[158:159]
  v_pk_add_f32 v[144:145], v[144:145], v[146:147]
  v_pk_add_f32 v[148:149], v[148:149], v[150:151]
  v_pk_add_f32 v[144:145], v[144:145], v[148:149]
  v_add_f32 v20, v144, v145
  v_mov_b32 v21, v20
  s_nop 1
  v_permlane16_swap_b32 v20, v21
  v_add_f32 v20, v20, v21
  v_mov_b32 v21, v20
  s_nop 1
  v_permlane32_swap_b32 v20, v21
  v_add_f32 v20, v20, v21
  s_mov_b64 exec, 3
  ds_write_b32 v54, v20 offset:2208
  s_mov_b64 exec, 1
  ds_add_u32 v4, v5 offset:276
  s_mov_b64 exec, -1
  v_mov_b32 v112, 0
  v_mov_b32 v113, 0
  v_mov_b32 v114, 0
  v_mov_b32 v115, 0
  v_mov_b32 v116, 0
  v_mov_b32 v117, 0
  v_mov_b32 v118, 0
  v_mov_b32 v119, 0
Lw_21:
  ds_read_b32 v15, v4 offset:276
  s_waitcnt lgkmcnt(0)
  v_readfirstlane_b32 s51, v15
  s_nop 0
  s_cmp_ge_i32 s51, 4
  s_cbranch_scc1 Lw_21d
  s_sub_u32 s50, s50, 1
  s_cbranch_scc0 Lw_21
  s_mov_b32 s50, 0
Lw_21d:
Lq_22:
  s_cmp_lg_u32 s45, 0
  s_cbranch_scc1 Lq_22d
  ds_read_b32 v37, v4 offset:268
  s_waitcnt lgkmcnt(0)
  v_readfirstlane_b32 s52, v37
  s_cmp_lg_u32 s45, 0
  s_cbranch_scc1 Lc_23
  s_mov_b32 s45, s52
  s_cmp_eq_u32 s52, 2
  s_cbranch_scc0 Lc_23
  s_mov_b32 exec_lo, 0x00010001
  s_mov_b32 exec_hi, 0x00010001
  buffer_store_dwordx4 v[224:227], v57, s[32:35], s65 offen sc1
  s_mov_b64 exec, -1
Lc_23:
  s_sub_u32 s50, s50, 1
  s_cbranch_scc0 Lq_22
  s_mov_b32 s50, 0
Lq_22d:
  ds_read_b128 v[64:67], v55 offset:2304
  ds_read_b128 v[68:71], v55 offset:2432
  ds_read_b128 v[72:75], v55 offset:2560
  ds_read_b128 v[76:79], v55 offset:2688
  ds_read_b128 v[80:83], v55 offset:2816
  ds_read_b128 v[84:87], v55 offset:2944
  ds_read_b128 v[88:91], v55 offset:3072
  ds_read_b128 v[92:95], v55 offset:3200
  ds_read_b128 v[24:27], v53 offset:2208
  v_mov_b32 v123, v6
  v_mov_b32 v30, 0
  v_mov_b32 v31, v6
  v_mov_b32 v28, v23
  s_waitcnt lgkmcnt(0)
  v_pk_add_f32 v[24:25], v[24:25], v[26:27]
  v_add_f32 v29, v24, v25
  s_cmp_ge_i32 s47, 114
  s_cbranch_scc1 Lw_24d
Lw_24:
  ds_read_b32 v15, v4 offset:0
  s_waitcnt lgkmcnt(0)
  v_readfirstlane_b32 s47, v15
  s_nop 0
  s_cmp_ge_i32 s47, 114
  s_cbranch_scc1 Lw_24d
  s_sub_u32 s50, s50, 1
  s_cbranch_scc0 Lw_24
  s_mov_b32 s50, 0
Lw_24d:
  ds_read_b64_tr_b16 v[160:161], v8 offset:0
  ds_read_b64_tr_b16 v[162:163], v8 offset:4096
  ds_read_b64_tr_b16 v[164:165], v9 offset:0
  ds_read_b64_tr_b16 v[166:167], v9 offset:4096
  ds_read_b64_tr_b16 v[168:169], v8 offset:8192
  ds_read_b64_tr_b16 v[170:171], v8 offset:12288
  ds_read_b64_tr_b16 v[172:173], v9 offset:8192
  ds_read_b64_tr_b16 v[174:175], v9 offset:12288
  ds_read_b64_tr_b16 v[176:177], v8 offset:16384
  ds_read_b64_tr_b16 v[178:179], v8 offset:20480
  ds_read_b64_tr_b16 v[180:181], v9 offset:16384
  ds_read_b64_tr_b16 v[182:183], v9 offset:20480
  ds_read_b64_tr_b16 v[184:185], v8 offset:24576
  ds_read_b64_tr_b16 v[186:187], v8 offset:28672
  ds_read_b64_tr_b16 v[188:189], v9 offset:24576
  ds_read_b64_tr_b16 v[190:191], v9 offset:28672
  s_waitcnt lgkmcnt(14)
  v_mfma_f32_16x16x32_bf16 v[112:115], v[160:163], v[64:67], v[112:115]
  s_waitcnt lgkmcnt(12)
  v_mfma_f32_16x16x32_bf16 v[116:119], v[164:167], v[64:67], v[116:119]
  s_waitcnt lgkmcnt(10)
  v_mfma_f32_16x16x32_bf16 v[112:115], v[168:171], v[68:71], v[112:115]
  s_waitcnt lgkmcnt(8)
  v_mfma_f32_16x16x32_bf16 v[116:119], v[172:175], v[68:71], v[116:119]
  s_waitcnt lgkmcnt(6)
  v_mfma_f32_16x16x32_bf16 v[112:115], v[176:179], v[72:75], v[112:115]
  s_waitcnt lgkmcnt(4)
  v_mfma_f32_16x16x32_bf16 v[116:119], v[180:183], v[72:75], v[116:119]
  s_waitcnt lgkmcnt(2)
  v_mfma_f32_16x16x32_bf16 v[112:115], v[184:187], v[76:79], v[112:115]
  s_waitcnt lgkmcnt(0)
  v_mfma_f32_16x16x32_bf16 v[116:119], v[188:191], v[76:79], v[116:119]
  s_cmp_ge_i32 s47, 130
  s_cbranch_scc1 Lw_25d
Lw_25:
  ds_read_b32 v15, v4 offset:0
  s_waitcnt lgkmcnt(0)
  v_readfirstlane_b32 s47, v15
  s_nop 0
  s_cmp_ge_i32 s47, 130
  s_cbranch_scc1 Lw_25d
  s_sub_u32 s50, s50, 1
  s_cbranch_scc0 Lw_25
  s_mov_b32 s50, 0
Lw_25d:
  ds_read_b64_tr_b16 v[192:193], v8 offset:32768
  ds_read_b64_tr_b16 v[194:195], v8 offset:36864
  ds_read_b64_tr_b16 v[196:197], v9 offset:32768
  ds_read_b64_tr_b16 v[198:199], v9 offset:36864
  ds_read_b64_tr_b16 v[200:201], v8 offset:40960
  ds_read_b64_tr_b16 v[202:203], v8 offset:45056
  ds_read_b64_tr_b16 v[204:205], v9 offset:40960
  ds_read_b64_tr_b16 v[206:207], v9 offset:45056
  s_waitcnt lgkmcnt(6)
  v_mfma_f32_16x16x32_bf16 v[112:115], v[192:195], v[80:83], v[112:115]
  s_waitcnt lgkmcnt(4)
  v_mfma_f32_16x16x32_bf16 v[116:119], v[196:199], v[80:83], v[116:119]
  s_waitcnt lgkmcnt(2)
  v_mfma_f32_16x16x32_bf16 v[112:115], v[200:203], v[84:87], v[112:115]
  s_waitcnt lgkmcnt(0)
  v_mfma_f32_16x16x32_bf16 v[116:119], v[204:207], v[84:87], v[116:119]
  s_cmp_ge_i32 s47, 138
  s_cbranch_scc1 Lw_26d
Lw_26:
  ds_read_b32 v15, v4 offset:0
  s_waitcnt lgkmcnt(0)
  v_readfirstlane_b32 s47, v15
  s_nop 0
  s_cmp_ge_i32 s47, 138
  s_cbranch_scc1 Lw_26d
  s_sub_u32 s50, s50, 1
  s_cbranch_scc0 Lw_26
  s_mov_b32 s50, 0
Lw_26d:
  ds_read_b64_tr_b16 v[208:209], v8 offset:49152
  ds_read_b64_tr_b16 v[210:211], v8 offset:53248
  ds_read_b64_tr_b16 v[212:213], v9 offset:49152
  ds_read_b64_tr_b16 v[214:215], v9 offset:53248
  s_waitcnt lgkmcnt(2)
  v_mfma_f32_16x16x32_bf16 v[112:115], v[208:211], v[88:91], v[112:115]
  s_waitcnt lgkmcnt(0)
  v_mfma_f32_16x16x32_bf16 v[116:119], v[212:215], v[88:91], v[116:119]
  s_cmp_ge_i32 s47, 146
  s_cbranch_scc1 Lw_27d
Lw_27:
  ds_read_b32 v15, v4 offset:0
  s_waitcnt lgkmcnt(0)
  v_readfirstlane_b32 s47, v15
  s_nop 0
  s_cmp_ge_i32 s47, 146
  s_cbranch_scc1 Lw_27d
  s_sub_u32 s50, s50, 1
  s_cbranch_scc0 Lw_27
  s_mov_b32 s50, 0
Lw_27d:
  ds_read_b64_tr_b16 v[216:217], v8 offset:57344
  ds_read_b64_tr_b16 v[218:219], v8 offset:61440
  ds_read_b64_tr_b16 v[220:221], v9 offset:57344
  ds_read_b64_tr_b16 v[222:223], v9 offset:61440
  s_waitcnt lgkmcnt(2)
  v_mfma_f32_16x16x32_bf16 v[112:115], v[216:219], v[92:95], v[112:115]
  s_waitcnt lgkmcnt(0)
  v_mfma_f32_16x16x32_bf16 v[116:119], v[220:223], v[92:95], v[116:119]
  s_mov_b32 s52, 0xcccccccc
  s_mov_b32 s53, 0xcccccccc
  s_nop 5
  v_cndmask_b32 v112, v112, v116, s[52:53]
  v_cndmask_b32 v113, v113, v117, s[52:53]
  v_cndmask_b32 v114, v114, v118, s[52:53]
  v_cndmask_b32 v115, v115, v119, s[52:53]
  s_mov_b32 exec_lo, 0x000f000f
  s_mov_b32 exec_hi, 0x000f000f
  v_perm_b32 v120, v112, v113, s60
  v_perm_b32 v121, v114, v113, s61
  v_perm_b32 v122, v115, v113, s62
  s_cmp_eq_u32 s45, 1
  s_cbranch_scc1 Ls_28p
  buffer_store_dwordx4 v[120:123], v58, s[32:35], s66 offen sc1
  s_branch Ls_28q
Ls_28p:
  buffer_store_dwordx4 v[120:123], v58, s[32:35], s66 offen
Ls_28q:
  s_cmp_eq_u32 s49, 0
  s_cbranch_scc0 L_noml
  s_mov_b64 exec, 0xffff
  s_cmp_eq_u32 s45, 1
  s_cbranch_scc1 Ls_29p
  buffer_store_dwordx4 v[28:31], v59, s[32:35], s67 offen sc1
  s_branch Ls_29q
Ls_29p:
  buffer_store_dwordx4 v[28:31], v59, s[32:35], s67 offen
Ls_29q:
L_noml:
  s_mov_b64 exec, -1
  s_mov_b64 exec, 1
  ds_add_u32 v4, v5 offset:260
  s_mov_b64 exec, -1
  s_cmp_lt_u32 s29, 18
  s_cbranch_scc1 L_F
  s_cmp_lt_u32 s29, 27
  s_cbranch_scc1 L_S
  s_cmp_eq_u32 s49, 0
  s_cbranch_scc0 L_fin
  s_mul_i32 s65, s28, 5
  s_add_u32 s65, s65, s29
  s_sub_u32 s65, s65, 27
  s_cmp_lt_u32 s65, 36
  s_cbranch_scc0 L_fin
  v_bfe_u32 v14, v1, 2, 3
  v_mul_u32_u24 v14, 2304, v14
  v_and_b32 v15, 3, v1
  v_lshl_add_u32 v14, v15, 4, v14
  s_lshl_b32 s66, s65, 6
  s_add_u32 s66, s66, 458752
Lg_30:
  s_sleep 4
  buffer_load_dwordx4 v[20:23], v14, s[32:35], s66 offen sc1
  s_waitcnt vmcnt(0)
  v_xor_b32 v36, v23, v6
  v_cmp_ne_u32 vcc, 0, v36
  s_cbranch_vccz Lg_30d
  s_sub_u32 s50, s50, 1
  s_cbranch_scc0 Lg_30
  s_mov_b32 s50, 0
Lg_30d:
  v_perm_b32 v24, v22, v21, s63
  v_perm_b32 v24, v24, v20, s64
  v_mov_b32 v25, v21
  v_mov_b32 v26, v22
  v_mov_b32 v23, v20
  s_nop 1
  v_add_f32_dpp v23, v23, v23 row_ror:4 row_mask:0xf bank_mask:0xf
  v_add_f32_dpp v24, v24, v24 row_ror:4 row_mask:0xf bank_mask:0xf
  v_add_f32_dpp v25, v25, v25 row_ror:4 row_mask:0xf bank_mask:0xf
  v_add_f32_dpp v26, v26, v26 row_ror:4 row_mask:0xf bank_mask:0xf
  v_add_f32_dpp v23, v23, v23 row_ror:8 row_mask:0xf bank_mask:0xf
  v_add_f32_dpp v24, v24, v24 row_ror:8 row_mask:0xf bank_mask:0xf
  v_add_f32_dpp v25, v25, v25 row_ror:8 row_mask:0xf bank_mask:0xf
  v_add_f32_dpp v26, v26, v26 row_ror:8 row_mask:0xf bank_mask:0xf
  v_mov_b32 v40, v23
  v_mov_b32 v41, v24
  v_mov_b32 v42, v25
  v_mov_b32 v43, v26
  v_permlane16_swap_b32 v23, v40
  v_permlane16_swap_b32 v24, v41
  v_permlane16_swap_b32 v25, v42
  v_permlane16_swap_b32 v26, v43
  v_add_f32 v23, v23, v40
  v_add_f32 v24, v24, v41
  v_add_f32 v25, v25, v42
  v_add_f32 v26, v26, v43
  v_cvt_pk_bf16_f32 v36, v23, v24
  v_lshlrev_b32 v23, 16, v36
  v_and_b32 v24, 0xffff0000, v36
  v_cvt_pk_bf16_f32 v36, v25, v26
  v_lshlrev_b32 v25, 16, v36
  v_and_b32 v26, 0xffff0000, v36
  v_lshlrev_b32 v28, 16, v16
  v_and_b32 v29, 0xffff0000, v16
  v_lshlrev_b32 v30, 16, v17
  v_and_b32 v31, 0xffff0000, v17
  v_add_f32 v28, v28, v23
  v_add_f32 v29, v29, v24
  v_add_f32 v30, v30, v25
  v_add_f32 v31, v31, v26
  v_cvt_pk_bf16_f32 v36, v28, v29
  v_lshlrev_b32 v28, 16, v36
  v_and_b32 v29, 0xffff0000, v36
  v_cvt_pk_bf16_f32 v36, v30, v31
  v_lshlrev_b32 v30, 16, v36
  v_and_b32 v31, 0xffff0000, v36
  v_lshlrev_b32 v14, 4, v1
  s_mul_i32 s66, s65, 9216
  s_add_u32 s66, s66, 589824
  s_add_u32 s67, s66, 4096
  s_add_u32 s68, s66, 8192
  s_lshl_b32 s69, s65, 5
  v_and_b32 v19, 3, v1
  v_lshlrev_b32 v19, 3, v19
  v_mov_b32 v18, 0
  buffer_load_dwordx4 v[64:67], v14, s[32:35], s66 offen offset:0 sc1
  buffer_load_dwordx4 v[68:71], v14, s[32:35], s66 offen offset:1024 sc1
  buffer_load_dwordx4 v[72:75], v14, s[32:35], s66 offen offset:2048 sc1
  buffer_load_dwordx4 v[76:79], v14, s[32:35], s66 offen offset:3072 sc1
  buffer_load_dwordx4 v[80:83], v14, s[32:35], s67 offen offset:0 sc1
  buffer_load_dwordx4 v[84:87], v14, s[32:35], s67 offen offset:1024 sc1
  buffer_load_dwordx4 v[88:91], v14, s[32:35], s67 offen offset:2048 sc1
  buffer_load_dwordx4 v[92:95], v14, s[32:35], s67 offen offset:3072 sc1
  buffer_load_dwordx4 v[96:99], v14, s[32:35], s68 offen offset:0 sc1
Lr_31:
  s_waitcnt vmcnt(0)
  v_xor_b32 v36, v67, v6
  v_bitop3_b32 v36, v71, v6, v36 bitop3:0xbe
  v_bitop3_b32 v36, v75, v6, v36 bitop3:0xbe
  v_bitop3_b32 v36, v79, v6, v36 bitop3:0xbe
  v_bitop3_b32 v36, v83, v6, v36 bitop3:0xbe
  v_bitop3_b32 v36, v87, v6, v36 bitop3:0xbe
  v_bitop3_b32 v36, v91, v6, v36 bitop3:0xbe
  v_bitop3_b32 v36, v95, v6, v36 bitop3:0xbe
  v_bitop3_b32 v36, v99, v6, v36 bitop3:0xbe
  v_cmp_ne_u32 vcc, 0, v36
  s_cbranch_vccz Lr_31s0
  buffer_load_dwordx4 v[64:67], v14, s[32:35], s66 offen offset:0 sc1
  buffer_load_dwordx4 v[68:71], v14, s[32:35], s66 offen offset:1024 sc1
  buffer_load_dwordx4 v[72:75], v14, s[32:35], s66 offen offset:2048 sc1
  buffer_load_dwordx4 v[76:79], v14, s[32:35], s66 offen offset:3072 sc1
  buffer_load_dwordx4 v[80:83], v14, s[32:35], s67 offen offset:0 sc1
  buffer_load_dwordx4 v[84:87], v14, s[32:35], s67 offen offset:1024 sc1
  buffer_load_dwordx4 v[88:91], v14, s[32:35], s67 offen offset:2048 sc1
  buffer_load_dwordx4 v[92:95], v14, s[32:35], s67 offen offset:3072 sc1
  buffer_load_dwordx4 v[96:99], v14, s[32:35], s68 offen offset:0 sc1
  s_sub_u32 s50, s50, 1
  s_cbranch_scc0 Lr_31
  s_mov_b32 s50, 0
Lr_31s0:
  v_perm_b32 v40, v66, v65, s63
  v_perm_b32 v40, v40, v64, s64
  v_perm_b32 v41, v70, v69, s63
  v_perm_b32 v41, v41, v68, s64
  v_perm_b32 v42, v74, v73, s63
  v_perm_b32 v42, v42, v72, s64
  v_perm_b32 v43, v78, v77, s63
  v_perm_b32 v43, v43, v76, s64
  v_perm_b32 v44, v82, v81, s63
  v_perm_b32 v44, v44, v80, s64
  v_perm_b32 v45, v86, v85, s63
  v_perm_b32 v45, v45, v84, s64
  v_perm_b32 v46, v90, v89, s63
  v_perm_b32 v46, v46, v88, s64
  v_perm_b32 v47, v94, v93, s63
  v_perm_b32 v47, v47, v92, s64
  v_perm_b32 v48, v98, v97, s63
  v_perm_b32 v48, v48, v96, s64
  v_pk_add_f32 v[64:65], v[64:65], v[68:69]
  v_pk_add_f32 v[64:65], v[64:65], v[72:73]
  v_pk_add_f32 v[64:65], v[64:65], v[76:77]
  v_pk_add_f32 v[64:65], v[64:65], v[80:81]
  v_pk_add_f32 v[64:65], v[64:65], v[84:85]
  v_pk_add_f32 v[64:65], v[64:65], v[88:89]
  v_pk_add_f32 v[64:65], v[64:65], v[92:93]
  v_pk_add_f32 v[64:65], v[64:65], v[96:97]
  v_pk_add_f32 v[40:41], v[40:41], v[42:43]
  v_pk_add_f32 v[40:41], v[40:41], v[44:45]
  v_pk_add_f32 v[40:41], v[40:41], v[46:47]
  v_add_f32 v33, v40, v41
  v_add_f32 v33, v33, v48
  v_add_f32 v35, v66, v70
  v_add_f32 v35, v35, v74
  v_add_f32 v35, v35, v78
  v_add_f32 v35, v35, v82
  v_add_f32 v35, v35, v86
  v_add_f32 v35, v35, v90
  v_add_f32 v35, v35, v94
  v_add_f32 v35, v35, v98
  v_mov_b32 v32, v64
  v_mov_b32 v34, v65
Lr_31j:
  s_nop 0
  v_add_f32_dpp v32, v32, v32 row_ror:4 row_mask:0xf bank_mask:0xf
  v_add_f32_dpp v33, v33, v33 row_ror:4 row_mask:0xf bank_mask:0xf
  v_add_f32_dpp v34, v34, v34 row_ror:4 row_mask:0xf bank_mask:0xf
  v_add_f32_dpp v35, v35, v35 row_ror:4 row_mask:0xf bank_mask:0xf
  v_add_f32_dpp v32, v32, v32 row_ror:8 row_mask:0xf bank_mask:0xf
  v_add_f32_dpp v33, v33, v33 row_ror:8 row_mask:0xf bank_mask:0xf
  v_add_f32_dpp v34, v34, v34 row_ror:8 row_mask:0xf bank_mask:0xf
  v_add_f32_dpp v35, v35, v35 row_ror:8 row_mask:0xf bank_mask:0xf
  v_mov_b32 v40, v32
  v_mov_b32 v41, v33
  v_mov_b32 v42, v34
  v_mov_b32 v43, v35
  v_permlane16_swap_b32 v32, v40
  v_permlane16_swap_b32 v33, v41
  v_permlane16_swap_b32 v34, v42
  v_permlane16_swap_b32 v35, v43
  v_pk_add_f32 v[32:33], v[32:33], v[40:41]
  v_pk_add_f32 v[34:35], v[34:35], v[42:43]
  v_mov_b32 v40, v32
  v_mov_b32 v41, v33
  v_mov_b32 v42, v34
  v_mov_b32 v43, v35
  v_permlane32_swap_b32 v32, v40
  v_permlane32_swap_b32 v33, v41
  v_permlane32_swap_b32 v34, v42
  v_permlane32_swap_b32 v35, v43
  v_pk_add_f32 v[32:33], v[32:33], v[40:41]
  v_pk_add_f32 v[34:35], v[34:35], v[42:43]
  v_cvt_pk_bf16_f32 v36, v32, v33
  v_lshlrev_b32 v32, 16, v36
  v_and_b32 v33, 0xffff0000, v36
  v_cvt_pk_bf16_f32 v37, v34, v35
  v_lshlrev_b32 v34, 16, v37
  v_and_b32 v35, 0xffff0000, v37
  v_pk_add_f32 v[32:33], v[32:33], v[28:29]
  v_pk_add_f32 v[34:35], v[34:35], v[30:31]
  v_cvt_pk_bf16_f32 v36, v32, v33
  v_cvt_pk_bf16_f32 v37, v34, v35
  s_mov_b64 exec, 15
  buffer_store_dwordx2 v[36:37], v19, s[40:43], s69 offen
  s_cmp_eq_u32 s65, 0
  s_cbranch_scc0 L_noep
  s_mov_b64 exec, 1
  buffer_store_dword v6, v18, s[32:35], 0 offen offset:0 sc1
L_noep:
  s_mov_b64 exec, -1
  s_branch L_fin
L_S:
  v_lshrrev_b32 v32, 2, v2
  v_and_b32 v33, 3, v2
  v_lshrrev_b32 v34, 1, v32
  v_and_b32 v35, 1, v3
  v_lshl_or_b32 v34, v35, 1, v34
  v_lshlrev_b32 v34, 5, v34
  v_lshl_add_u32 v34, v33, 3, v34
  v_lshl_add_u32 v34, v32, 7, v34
  v_lshl_add_u32 v34, v3, 11, v34
  s_lshl_b32 s51, s49, 14
  v_add_u32 v28, s51, v34
  v_xor_b32 v29, 32, v28
  v_xor_b32 v30, 64, v28
  v_xor_b32 v31, 96, v28
  s_lshl_b32 s65, s28, 2
  s_add_u32 s65, s65, s49
  s_lshl_b32 s66, s65, 13
  s_add_u32 s66, s66, 131072
  s_lshl_b32 s68, s65, 11
  s_add_u32 s68, s68, 393216
  v_bfe_u32 v14, v1, 2, 2
  v_lshlrev_b32 v14, 11, v14
  v_lshl_add_u32 v14, v3, 6, v14
  v_and_b32 v35, 3, v1
  v_lshl_add_u32 v14, v35, 4, v14
  v_lshlrev_b32 v41, 7, v2
  v_lshlrev_b32 v18, 4, v2
  s_lshl_b32 s51, s49, 8
  v_lshl_add_u32 v19, v3, 4, s51
  v_add_u32 v19, v19, v4
  v_add_u32 v40, v18, v4
  s_mul_i32 s69, s28, 2304
  s_sub_u32 s52, s29, 18
  s_lshl_b32 s52, s52, 8
  s_add_u32 s69, s69, s52
  s_add_u32 s69, s69, 458752
  s_mov_b32 s54, 0x3fb8aa3b
  v_mov_b32 v192, 0
  v_mov_b32 v193, 0
  v_mov_b32 v194, 0
  v_mov_b32 v195, 0
  v_mov_b32 v196, 0
  v_mov_b32 v197, 0
  v_mov_b32 v198, 0
  v_mov_b32 v199, 0
  v_mov_b32 v200, 0
  v_mov_b32 v201, 0
  v_mov_b32 v202, 0
  v_mov_b32 v203, 0
  v_mov_b32 v204, 0
  v_mov_b32 v205, 0
  v_mov_b32 v206, 0
  v_mov_b32 v207, 0
  v_mov_b32 v211, v6
  v_lshlrev_b32 v38, 4, v1
  s_cmp_ge_i32 s47, 210
  s_cbranch_scc1 Lw_32d
Lw_32:
  ds_read_b32 v15, v4 offset:0
  s_waitcnt lgkmcnt(0)
  v_readfirstlane_b32 s47, v15
  s_nop 0
  s_cmp_ge_i32 s47, 210
  s_cbranch_scc1 Lw_32d
  s_sub_u32 s50, s50, 1
  s_cbranch_scc0 Lw_32
  s_mov_b32 s50, 0
Lw_32d:
  ds_read_b64_tr_b16 v[64:65], v28 offset:0
  ds_read_b64_tr_b16 v[66:67], v28 offset:512
  ds_read_b64_tr_b16 v[68:69], v28 offset:1024
  ds_read_b64_tr_b16 v[70:71], v28 offset:1536
  ds_read_b64_tr_b16 v[72:73], v28 offset:8192
  ds_read_b64_tr_b16 v[74:75], v28 offset:8704
  ds_read_b64_tr_b16 v[76:77], v28 offset:9216
  ds_read_b64_tr_b16 v[78:79], v28 offset:9728
  ds_read_b64_tr_b16 v[80:81], v29 offset:0
  ds_read_b64_tr_b16 v[82:83], v29 offset:512
  ds_read_b64_tr_b16 v[84:85], v29 offset:1024
  ds_read_b64_tr_b16 v[86:87], v29 offset:1536
  ds_read_b64_tr_b16 v[88:89], v29 offset:8192
  ds_read_b64_tr_b16 v[90:91], v29 offset:8704
  ds_read_b64_tr_b16 v[92:93], v29 offset:9216
  ds_read_b64_tr_b16 v[94:95], v29 offset:9728
  ds_read_b64_tr_b16 v[96:97], v30 offset:0
  ds_read_b64_tr_b16 v[98:99], v30 offset:512
  ds_read_b64_tr_b16 v[100:101], v30 offset:1024
  ds_read_b64_tr_b16 v[102:103], v30 offset:1536
  ds_read_b64_tr_b16 v[104:105], v30 offset:8192
  ds_read_b64_tr_b16 v[106:107], v30 offset:8704
  ds_read_b64_tr_b16 v[108:109], v30 offset:9216
  ds_read_b64_tr_b16 v[110:111], v30 offset:9728
  ds_read_b64_tr_b16 v[112:113], v31 offset:0
  ds_read_b64_tr_b16 v[114:115], v31 offset:512
  ds_read_b64_tr_b16 v[116:117], v31 offset:1024
  ds_read_b64_tr_b16 v[118:119], v31 offset:1536
  ds_read_b64_tr_b16 v[120:121], v31 offset:8192
  ds_read_b64_tr_b16 v[122:123], v31 offset:8704
  ds_read_b64_tr_b16 v[124:125], v31 offset:9216
  ds_read_b64_tr_b16 v[126:127], v31 offset:9728
  buffer_load_dwordx4 v[128:131], v41, s[32:35], s68 offen sc1
  buffer_load_dwordx4 v[132:135], v14, s[32:35], s66 offen offset:0 sc1
  buffer_load_dwordx4 v[136:139], v14, s[32:35], s66 offen offset:512 sc1
  buffer_load_dwordx4 v[140:143], v14, s[32:35], s66 offen offset:1024 sc1
  buffer_load_dwordx4 v[144:147], v14, s[32:35], s66 offen offset:1536 sc1
  buffer_load_dwordx4 v[148:151], v14, s[32:35], s66 offen offset:256 sc1
  buffer_load_dwordx4 v[152:155], v14, s[32:35], s66 offen offset:768 sc1
  buffer_load_dwordx4 v[156:159], v14, s[32:35], s66 offen offset:1280 sc1
  buffer_load_dwordx4 v[160:163], v14, s[32:35], s66 offen offset:1792 sc1
Lr_33:
  s_waitcnt vmcnt(8)
  v_mov_b32 v32, v128
  s_nop 1
  v_max_f32_dpp v32, v32, v32 row_ror:8 row_mask:0xf bank_mask:0xf
  s_nop 1
  v_max_f32_dpp v32, v32, v32 row_ror:4 row_mask:0xf bank_mask:0xf
  s_nop 1
  v_max_f32_dpp v32, v32, v32 row_ror:2 row_mask:0xf bank_mask:0xf
  s_nop 1
  v_max_f32_dpp v32, v32, v32 row_ror:1 row_mask:0xf bank_mask:0xf
  v_sub_f32 v33, v128, v32
  v_mul_f32 v33, s54, v33
  v_exp_f32 v33, v33
  s_nop 0
  v_mul_f32 v34, v33, v129
  s_nop 1
  v_add_f32_dpp v34, v34, v34 row_ror:8 row_mask:0xf bank_mask:0xf
  s_nop 1
  v_add_f32_dpp v34, v34, v34 row_ror:4 row_mask:0xf bank_mask:0xf
  s_nop 1
  v_add_f32_dpp v34, v34, v34 row_ror:2 row_mask:0xf bank_mask:0xf
  s_nop 1
  v_add_f32_dpp v34, v34, v34 row_ror:1 row_mask:0xf bank_mask:0xf
  v_rcp_f32 v34, v34
  s_nop 0
  v_mul_f32 v33, v33, v34
  s_waitcnt vmcnt(0)
  v_xor_b32 v32, v131, v6
  v_bitop3_b32 v32, v135, v6, v32 bitop3:0xbe
  v_bitop3_b32 v32, v139, v6, v32 bitop3:0xbe
  v_bitop3_b32 v32, v143, v6, v32 bitop3:0xbe
  v_bitop3_b32 v32, v147, v6, v32 bitop3:0xbe
  v_bitop3_b32 v32, v151, v6, v32 bitop3:0xbe
  v_bitop3_b32 v32, v155, v6, v32 bitop3:0xbe
  v_bitop3_b32 v32, v159, v6, v32 bitop3:0xbe
  v_bitop3_b32 v32, v163, v6, v32 bitop3:0xbe
  v_cmp_ne_u32 vcc, 0, v32
  s_cbranch_vccz Lr_33s0
  buffer_load_dwordx4 v[128:131], v41, s[32:35], s68 offen sc1
  buffer_load_dwordx4 v[132:135], v14, s[32:35], s66 offen offset:0 sc1
  buffer_load_dwordx4 v[136:139], v14, s[32:35], s66 offen offset:512 sc1
  buffer_load_dwordx4 v[140:143], v14, s[32:35], s66 offen offset:1024 sc1
  buffer_load_dwordx4 v[144:147], v14, s[32:35], s66 offen offset:1536 sc1
  buffer_load_dwordx4 v[148:151], v14, s[32:35], s66 offen offset:256 sc1
  buffer_load_dwordx4 v[152:155], v14, s[32:35], s66 offen offset:768 sc1
  buffer_load_dwordx4 v[156:159], v14, s[32:35], s66 offen offset:1280 sc1
  buffer_load_dwordx4 v[160:163], v14, s[32:35], s66 offen offset:1792 sc1
  s_sub_u32 s50, s50, 1
  s_cbranch_scc0 Lr_33
  s_mov_b32 s50, 0
Lr_33s0:
  v_perm_b32 v164, v134, v133, s63
  v_perm_b32 v164, v164, v132, s64
  v_perm_b32 v165, v138, v137, s63
  v_perm_b32 v165, v165, v136, s64
  v_perm_b32 v166, v142, v141, s63
  v_perm_b32 v166, v166, v140, s64
  v_perm_b32 v167, v146, v145, s63
  v_perm_b32 v167, v167, v144, s64
  v_perm_b32 v168, v150, v149, s63
  v_perm_b32 v168, v168, v148, s64
  v_perm_b32 v169, v154, v153, s63
  v_perm_b32 v169, v169, v152, s64
  v_perm_b32 v170, v158, v157, s63
  v_perm_b32 v170, v170, v156, s64
  v_perm_b32 v171, v162, v161, s63
  v_perm_b32 v171, v171, v160, s64
  v_mul_f32_dpp v172, v33, v132 quad_perm:[0,0,0,0] row_mask:0xf bank_mask:0xf
  v_mul_f32_dpp v173, v33, v164 quad_perm:[0,0,0,0] row_mask:0xf bank_mask:0xf
  v_mul_f32_dpp v174, v33, v133 quad_perm:[0,0,0,0] row_mask:0xf bank_mask:0xf
  v_mul_f32_dpp v175, v33, v134 quad_perm:[0,0,0,0] row_mask:0xf bank_mask:0xf
  v_mul_f32_dpp v176, v33, v148 quad_perm:[0,0,0,0] row_mask:0xf bank_mask:0xf
  v_mul_f32_dpp v177, v33, v168 quad_perm:[0,0,0,0] row_mask:0xf bank_mask:0xf
  v_mul_f32_dpp v178, v33, v149 quad_perm:[0,0,0,0] row_mask:0xf bank_mask:0xf
  v_mul_f32_dpp v179, v33, v150 quad_perm:[0,0,0,0] row_mask:0xf bank_mask:0xf
  v_fmac_f32_dpp v172, v33, v136 quad_perm:[1,1,1,1] row_mask:0xf bank_mask:0xf
  v_fmac_f32_dpp v173, v33, v165 quad_perm:[1,1,1,1] row_mask:0xf bank_mask:0xf
  v_fmac_f32_dpp v174, v33, v137 quad_perm:[1,1,1,1] row_mask:0xf bank_mask:0xf
  v_fmac_f32_dpp v175, v33, v138 quad_perm:[1,1,1,1] row_mask:0xf bank_mask:0xf
  v_fmac_f32_dpp v176, v33, v152 quad_perm:[1,1,1,1] row_mask:0xf bank_mask:0xf
  v_fmac_f32_dpp v177, v33, v169 quad_perm:[1,1,1,1] row_mask:0xf bank_mask:0xf
  v_fmac_f32_dpp v178, v33, v153 quad_perm:[1,1,1,1] row_mask:0xf bank_mask:0xf
  v_fmac_f32_dpp v179, v33, v154 quad_perm:[1,1,1,1] row_mask:0xf bank_mask:0xf
  v_fmac_f32_dpp v172, v33, v140 quad_perm:[2,2,2,2] row_mask:0xf bank_mask:0xf
  v_fmac_f32_dpp v173, v33, v166 quad_perm:[2,2,2,2] row_mask:0xf bank_mask:0xf
  v_fmac_f32_dpp v174, v33, v141 quad_perm:[2,2,2,2] row_mask:0xf bank_mask:0xf
  v_fmac_f32_dpp v175, v33, v142 quad_perm:[2,2,2,2] row_mask:0xf bank_mask:0xf
  v_fmac_f32_dpp v176, v33, v156 quad_perm:[2,2,2,2] row_mask:0xf bank_mask:0xf
  v_fmac_f32_dpp v177, v33, v170 quad_perm:[2,2,2,2] row_mask:0xf bank_mask:0xf
  v_fmac_f32_dpp v178, v33, v157 quad_perm:[2,2,2,2] row_mask:0xf bank_mask:0xf
  v_fmac_f32_dpp v179, v33, v158 quad_perm:[2,2,2,2] row_mask:0xf bank_mask:0xf
  v_fmac_f32_dpp v172, v33, v144 quad_perm:[3,3,3,3] row_mask:0xf bank_mask:0xf
  v_fmac_f32_dpp v173, v33, v167 quad_perm:[3,3,3,3] row_mask:0xf bank_mask:0xf
  v_fmac_f32_dpp v174, v33, v145 quad_perm:[3,3,3,3] row_mask:0xf bank_mask:0xf
  v_fmac_f32_dpp v175, v33, v146 quad_perm:[3,3,3,3] row_mask:0xf bank_mask:0xf
  v_fmac_f32_dpp v176, v33, v160 quad_perm:[3,3,3,3] row_mask:0xf bank_mask:0xf
  v_fmac_f32_dpp v177, v33, v171 quad_perm:[3,3,3,3] row_mask:0xf bank_mask:0xf
  v_fmac_f32_dpp v178, v33, v161 quad_perm:[3,3,3,3] row_mask:0xf bank_mask:0xf
  v_fmac_f32_dpp v179, v33, v162 quad_perm:[3,3,3,3] row_mask:0xf bank_mask:0xf
Lr_33j:
  v_add_f32_dpp v172, v172, v172 row_ror:4 row_mask:0xf bank_mask:0xf
  v_add_f32_dpp v173, v173, v173 row_ror:4 row_mask:0xf bank_mask:0xf
  v_add_f32_dpp v174, v174, v174 row_ror:4 row_mask:0xf bank_mask:0xf
  v_add_f32_dpp v175, v175, v175 row_ror:4 row_mask:0xf bank_mask:0xf
  v_add_f32_dpp v176, v176, v176 row_ror:4 row_mask:0xf bank_mask:0xf
  v_add_f32_dpp v177, v177, v177 row_ror:4 row_mask:0xf bank_mask:0xf
  v_add_f32_dpp v178, v178, v178 row_ror:4 row_mask:0xf bank_mask:0xf
  v_add_f32_dpp v179, v179, v179 row_ror:4 row_mask:0xf bank_mask:0xf
  v_add_f32_dpp v172, v172, v172 row_ror:8 row_mask:0xf bank_mask:0xf
  v_add_f32_dpp v173, v173, v173 row_ror:8 row_mask:0xf bank_mask:0xf
  v_add_f32_dpp v174, v174, v174 row_ror:8 row_mask:0xf bank_mask:0xf
  v_add_f32_dpp v175, v175, v175 row_ror:8 row_mask:0xf bank_mask:0xf
  v_add_f32_dpp v176, v176, v176 row_ror:8 row_mask:0xf bank_mask:0xf
  v_add_f32_dpp v177, v177, v177 row_ror:8 row_mask:0xf bank_mask:0xf
  v_add_f32_dpp v178, v178, v178 row_ror:8 row_mask:0xf bank_mask:0xf
  v_add_f32_dpp v179, v179, v179 row_ror:8 row_mask:0xf bank_mask:0xf
  v_cvt_pk_bf16_f32 v180, v172, v173
  v_cvt_pk_bf16_f32 v181, v174, v175
  v_cvt_pk_bf16_f32 v182, v176, v177
  v_cvt_pk_bf16_f32 v183, v178, v179
  s_waitcnt lgkmcnt(0)
  v_mov_b32_dpp v184, v180 row_newbcast:0 row_mask:0xf bank_mask:0xf
  v_mov_b32_dpp v185, v181 row_newbcast:0 row_mask:0xf bank_mask:0xf
  v_mov_b32_dpp v186, v180 row_newbcast:1 row_mask:0xf bank_mask:0xf
  v_mov_b32_dpp v187, v181 row_newbcast:1 row_mask:0xf bank_mask:0xf
  s_nop 1
  v_mfma_f32_16x16x32_bf16 v[192:195], v[64:67], v[184:187], v[192:195]
  v_mov_b32_dpp v188, v180 row_newbcast:2 row_mask:0xf bank_mask:0xf
  v_mfma_f32_16x16x32_bf16 v[196:199], v[80:83], v[184:187], v[196:199]
  v_mov_b32_dpp v189, v181 row_newbcast:2 row_mask:0xf bank_mask:0xf
  v_mfma_f32_16x16x32_bf16 v[200:203], v[96:99], v[184:187], v[200:203]
  v_mov_b32_dpp v190, v180 row_newbcast:3 row_mask:0xf bank_mask:0xf
  v_mfma_f32_16x16x32_bf16 v[204:207], v[112:115], v[184:187], v[204:207]
  v_mov_b32_dpp v191, v181 row_newbcast:3 row_mask:0xf bank_mask:0xf
  s_nop 1
  v_mfma_f32_16x16x32_bf16 v[192:195], v[68:71], v[188:191], v[192:195]
  v_mov_b32_dpp v164, v182 row_newbcast:0 row_mask:0xf bank_mask:0xf
  v_mfma_f32_16x16x32_bf16 v[196:199], v[84:87], v[188:191], v[196:199]
  v_mov_b32_dpp v165, v183 row_newbcast:0 row_mask:0xf bank_mask:0xf
  v_mfma_f32_16x16x32_bf16 v[200:203], v[100:103], v[188:191], v[200:203]
  v_mov_b32_dpp v166, v182 row_newbcast:1 row_mask:0xf bank_mask:0xf
  v_mfma_f32_16x16x32_bf16 v[204:207], v[116:119], v[188:191], v[204:207]
  v_mov_b32_dpp v167, v183 row_newbcast:1 row_mask:0xf bank_mask:0xf
  s_nop 1
  v_mfma_f32_16x16x32_bf16 v[192:195], v[72:75], v[164:167], v[192:195]
  v_mov_b32_dpp v168, v182 row_newbcast:2 row_mask:0xf bank_mask:0xf
  v_mfma_f32_16x16x32_bf16 v[196:199], v[88:91], v[164:167], v[196:199]
  v_mov_b32_dpp v169, v183 row_newbcast:2 row_mask:0xf bank_mask:0xf
  v_mfma_f32_16x16x32_bf16 v[200:203], v[104:107], v[164:167], v[200:203]
  v_mov_b32_dpp v170, v182 row_newbcast:3 row_mask:0xf bank_mask:0xf
  v_mfma_f32_16x16x32_bf16 v[204:207], v[120:123], v[164:167], v[204:207]
  v_mov_b32_dpp v171, v183 row_newbcast:3 row_mask:0xf bank_mask:0xf
  s_nop 1
  v_mfma_f32_16x16x32_bf16 v[192:195], v[76:79], v[168:171], v[192:195]
  v_mfma_f32_16x16x32_bf16 v[196:199], v[92:95], v[168:171], v[196:199]
  v_mfma_f32_16x16x32_bf16 v[200:203], v[108:111], v[168:171], v[200:203]
  v_mfma_f32_16x16x32_bf16 v[204:207], v[124:127], v[168:171], v[204:207]
  s_mov_b32 exec_lo, 0x00010001
  s_mov_b32 exec_hi, 0x00010001
  s_nop 2
  ds_write_b128 v19, v[192:195] offset:4480
  ds_write_b128 v19, v[196:199] offset:4544
  ds_write_b128 v19, v[200:203] offset:4608
  ds_write_b128 v19, v[204:207] offset:4672
  s_waitcnt lgkmcnt(0)
  s_mov_b64 exec, -1
  s_barrier
  s_cmp_eq_u32 s49, 0
  s_cbranch_scc0 L_fin
  ds_read_b128 v[64:67], v40 offset:4480
  ds_read_b128 v[68:71], v40 offset:4736
  ds_read_b128 v[72:75], v40 offset:4992
  ds_read_b128 v[76:79], v40 offset:5248
  s_waitcnt lgkmcnt(0)
  v_pk_add_f32 v[64:65], v[64:65], v[68:69]
  v_pk_add_f32 v[72:73], v[72:73], v[76:77]
  v_pk_add_f32 v[66:67], v[66:67], v[70:71]
  v_pk_add_f32 v[74:75], v[74:75], v[78:79]
  v_pk_add_f32 v[64:65], v[64:65], v[72:73]
  v_pk_add_f32 v[66:67], v[66:67], v[74:75]
  s_mov_b64 exec, 0xffff
  v_perm_b32 v208, v64, v65, s60
  v_perm_b32 v209, v66, v65, s61
  v_perm_b32 v210, v67, v65, s62
  buffer_store_dwordx4 v[208:211], v18, s[32:35], s69 offen sc1
  s_mov_b64 exec, -1
  s_branch L_fin
L_F:
  s_and_b32 s65, s29, 1
  s_lshr_b32 s66, s29, 1
  s_mul_i32 s67, s28, 9
  s_add_u32 s66, s66, s67
  v_add_u32 v19, 36864, v7
  v_lshlrev_b32 v40, 1, v18
  v_lshrrev_b32 v14, 3, v18
  v_lshrrev_b32 v34, 3, v14
  v_lshlrev_b32 v34, 6, v34
  v_and_b32 v35, 3, v14
  v_lshl_add_u32 v34, v35, 4, v34
  v_bfe_u32 v35, v14, 2, 1
  v_lshl_add_u32 v34, v35, 3, v34
  v_add_u32 v41, v34, v4
  v_lshl_add_u32 v42, v3, 4, v4
  s_lshl_b32 s51, s49, 3
  v_add_u32 v43, s51, v4
  v_and_b32 v44, 1, v3
  v_lshlrev_b32 v44, 4, v44
  v_and_b32 v62, 3, v2
  v_lshl_add_u32 v62, v62, 5, v44
  v_and_b32 v45, 1, v3
  v_lshlrev_b32 v45, 3, v45
  v_and_b32 v38, 3, v2
  v_lshl_add_u32 v45, v38, 1, v45
  s_lshl_b32 s51, s49, 4
  v_add_u32 v45, s51, v45
  v_add_u32 v45, v45, v4
  v_mul_u32_u24 v46, 36864, v2
  v_lshl_add_u32 v46, v3, 4, v46
  v_lshrrev_b32 v28, 2, v2
  v_and_b32 v29, 3, v2
  v_lshrrev_b32 v30, 1, v28
  v_and_b32 v31, 1, v3
  v_lshlrev_b32 v31, 1, v31
  v_xor_b32 v30, v30, v31
  v_xor_b32 v30, s49, v30
  v_lshlrev_b32 v30, 5, v30
  v_lshl_add_u32 v30, v29, 3, v30
  v_lshl_add_u32 v30, v28, 7, v30
  v_lshl_add_u32 v30, v3, 10, v30
  v_add_u32 v47, 83968, v30
  v_xor_b32 v30, 64, v30
  v_add_u32 v48, 84480, v30
  v_lshlrev_b32 v50, 16, v16
  v_and_b32 v51, 0xffff0000, v16
  v_lshlrev_b32 v52, 16, v17
  v_and_b32 v53, 0xffff0000, v17
  s_lshl_b32 s67, s66, 10
  s_lshl_b32 s68, s49, 7
  s_add_u32 s67, s67, s68
  s_add_u32 s67, s67, 491520
  s_lshl_b32 s68, s65, 9
  s_add_u32 s69, s67, s68
  s_xor_b32 s68, s68, 512
  s_add_u32 s70, s67, s68
  s_mul_i32 s51, s28, 18
  s_add_u32 s51, s51, s29
  s_lshl_b32 s51, s51, 6
  s_mul_i32 s52, s49, 9216
  s_add_u32 s51, s51, s52
  s_add_u32 s68, s51, 589824
  s_mov_b32 s66, 458752
  s_mov_b32 s67, 467968
  v_mov_b32 v24, 0x3f803f80
  v_mov_b32 v25, v24
  v_mov_b32 v26, v24
  v_mov_b32 v27, v24
  v_mov_b32 v20, 0
  v_mov_b32 v54, 0
  v_mov_b32 v21, 0
  v_mov_b32 v55, 0
  v_mov_b32 v22, 0
  v_mov_b32 v56, 0
  v_mov_b32 v23, 0
  v_mov_b32 v57, 0
  v_mov_b32 v60, 0
  v_mov_b32 v61, 0
  v_add_u32 v49, 4608, v40
  buffer_load_dwordx4 v[244:247], v44, s[32:35], s69 offen sc1
  s_cmp_ge_i32 s47, 158
  s_cbranch_scc1 Lw_34d
Lw_34:
  ds_read_b32 v15, v4 offset:0
  s_waitcnt lgkmcnt(0)
  v_readfirstlane_b32 s47, v15
  s_nop 0
  s_cmp_ge_i32 s47, 158
  s_cbranch_scc1 Lw_34d
  s_sub_u32 s50, s50, 1
  s_cbranch_scc0 Lw_34
  s_mov_b32 s50, 0
Lw_34d:
  ds_read_b64_tr_b16 v[64:65], v7 offset:0
  ds_read_b64_tr_b16 v[66:67], v7 offset:2048
  ds_read_b64_tr_b16 v[68:69], v7 offset:4096
  ds_read_b64_tr_b16 v[70:71], v7 offset:6144
  ds_read_b64_tr_b16 v[72:73], v7 offset:8192
  ds_read_b64_tr_b16 v[74:75], v7 offset:10240
  s_waitcnt lgkmcnt(4)
  v_mfma_f32_16x16x32_bf16 v[54:57], v[64:67], v[24:27], v[54:57]
  s_waitcnt lgkmcnt(2)
  v_mfma_f32_16x16x32_bf16 v[54:57], v[68:71], v[24:27], v[54:57]
  s_waitcnt lgkmcnt(0)
  v_mfma_f32_16x16x32_bf16 v[54:57], v[72:75], v[24:27], v[54:57]
  s_cmp_ge_i32 s47, 170
  s_cbranch_scc1 Lw_35d
Lw_35:
  ds_read_b32 v15, v4 offset:0
  s_waitcnt lgkmcnt(0)
  v_readfirstlane_b32 s47, v15
  s_nop 0
  s_cmp_ge_i32 s47, 170
  s_cbranch_scc1 Lw_35d
  s_sub_u32 s50, s50, 1
  s_cbranch_scc0 Lw_35
  s_mov_b32 s50, 0
Lw_35d:
  ds_read_b64_tr_b16 v[76:77], v7 offset:12288
  ds_read_b64_tr_b16 v[78:79], v7 offset:14336
  ds_read_b64_tr_b16 v[80:81], v7 offset:16384
  ds_read_b64_tr_b16 v[82:83], v7 offset:18432
  ds_read_b64_tr_b16 v[84:85], v7 offset:20480
  ds_read_b64_tr_b16 v[86:87], v7 offset:22528
  s_waitcnt lgkmcnt(4)
  v_mfma_f32_16x16x32_bf16 v[54:57], v[76:79], v[24:27], v[54:57]
  s_waitcnt lgkmcnt(2)
  v_mfma_f32_16x16x32_bf16 v[54:57], v[80:83], v[24:27], v[54:57]
  s_waitcnt lgkmcnt(0)
  v_mfma_f32_16x16x32_bf16 v[54:57], v[84:87], v[24:27], v[54:57]
  s_cmp_ge_i32 s47, 182
  s_cbranch_scc1 Lw_36d
Lw_36:
  ds_read_b32 v15, v4 offset:0
  s_waitcnt lgkmcnt(0)
  v_readfirstlane_b32 s47, v15
  s_nop 0
  s_cmp_ge_i32 s47, 182
  s_cbranch_scc1 Lw_36d
  s_sub_u32 s50, s50, 1
  s_cbranch_scc0 Lw_36
  s_mov_b32 s50, 0
Lw_36d:
  ds_read_b64_tr_b16 v[88:89], v7 offset:24576
  ds_read_b64_tr_b16 v[90:91], v7 offset:26624
  ds_read_b64_tr_b16 v[92:93], v7 offset:28672
  ds_read_b64_tr_b16 v[94:95], v7 offset:30720
  ds_read_b64_tr_b16 v[96:97], v7 offset:32768
  ds_read_b64_tr_b16 v[98:99], v7 offset:34816
  s_waitcnt lgkmcnt(4)
  v_mfma_f32_16x16x32_bf16 v[54:57], v[88:91], v[24:27], v[54:57]
  s_waitcnt lgkmcnt(2)
  v_mfma_f32_16x16x32_bf16 v[54:57], v[92:95], v[24:27], v[54:57]
  s_waitcnt lgkmcnt(0)
  v_mfma_f32_16x16x32_bf16 v[54:57], v[96:99], v[24:27], v[54:57]
  s_cmp_ge_i32 s47, 194
  s_cbranch_scc1 Lw_37d
Lw_37:
  ds_read_b32 v15, v4 offset:0
  s_waitcnt lgkmcnt(0)
  v_readfirstlane_b32 s47, v15
  s_nop 0
  s_cmp_ge_i32 s47, 194
  s_cbranch_scc1 Lw_37d
  s_sub_u32 s50, s50, 1
  s_cbranch_scc0 Lw_37
  s_mov_b32 s50, 0
Lw_37d:
  ds_read_b64_tr_b16 v[100:101], v19 offset:0
  ds_read_b64_tr_b16 v[102:103], v19 offset:2048
  ds_read_b64_tr_b16 v[104:105], v19 offset:4096
  ds_read_b64_tr_b16 v[106:107], v19 offset:6144
  ds_read_b64_tr_b16 v[108:109], v19 offset:8192
  ds_read_b64_tr_b16 v[110:111], v19 offset:10240
  s_waitcnt lgkmcnt(4)
  v_mfma_f32_16x16x32_bf16 v[54:57], v[100:103], v[24:27], v[54:57]
  s_waitcnt lgkmcnt(2)
  v_mfma_f32_16x16x32_bf16 v[54:57], v[104:107], v[24:27], v[54:57]
  s_waitcnt lgkmcnt(0)
  v_mfma_f32_16x16x32_bf16 v[54:57], v[108:111], v[24:27], v[54:57]
  s_cmp_ge_i32 s47, 206
  s_cbranch_scc1 Lw_38d
Lw_38:
  ds_read_b32 v15, v4 offset:0
  s_waitcnt lgkmcnt(0)
  v_readfirstlane_b32 s47, v15
  s_nop 0
  s_cmp_ge_i32 s47, 206
  s_cbranch_scc1 Lw_38d
  s_sub_u32 s50, s50, 1
  s_cbranch_scc0 Lw_38
  s_mov_b32 s50, 0
Lw_38d:
  ds_read_b64_tr_b16 v[112:113], v19 offset:12288
  ds_read_b64_tr_b16 v[114:115], v19 offset:14336
  ds_read_b64_tr_b16 v[116:117], v19 offset:16384
  ds_read_b64_tr_b16 v[118:119], v19 offset:18432
  ds_read_b64_tr_b16 v[120:121], v19 offset:20480
  ds_read_b64_tr_b16 v[122:123], v19 offset:22528
  s_waitcnt lgkmcnt(4)
  v_mfma_f32_16x16x32_bf16 v[54:57], v[112:115], v[24:27], v[54:57]
  s_waitcnt lgkmcnt(2)
  v_mfma_f32_16x16x32_bf16 v[54:57], v[116:119], v[24:27], v[54:57]
  s_waitcnt lgkmcnt(0)
  v_mfma_f32_16x16x32_bf16 v[54:57], v[120:123], v[24:27], v[54:57]
  s_cmp_ge_i32 s47, 218
  s_cbranch_scc1 Lw_39d
Lw_39:
  ds_read_b32 v15, v4 offset:0
  s_waitcnt lgkmcnt(0)
  v_readfirstlane_b32 s47, v15
  s_nop 0
  s_cmp_ge_i32 s47, 218
  s_cbranch_scc1 Lw_39d
  s_sub_u32 s50, s50, 1
  s_cbranch_scc0 Lw_39
  s_mov_b32 s50, 0
Lw_39d:
  ds_read_b64_tr_b16 v[124:125], v19 offset:24576
  ds_read_b64_tr_b16 v[126:127], v19 offset:26624
  ds_read_b64_tr_b16 v[128:129], v19 offset:28672
  ds_read_b64_tr_b16 v[130:131], v19 offset:30720
  ds_read_b64_tr_b16 v[132:133], v19 offset:32768
  ds_read_b64_tr_b16 v[134:135], v19 offset:34816
  s_waitcnt lgkmcnt(4)
  v_mfma_f32_16x16x32_bf16 v[54:57], v[124:127], v[24:27], v[54:57]
  s_waitcnt lgkmcnt(2)
  v_mfma_f32_16x16x32_bf16 v[54:57], v[128:131], v[24:27], v[54:57]
  s_waitcnt lgkmcnt(0)
  v_mfma_f32_16x16x32_bf16 v[54:57], v[132:135], v[24:27], v[54:57]
Lg_40:
  buffer_load_dwordx4 v[208:211], v40, s[32:35], s66 offen offset:0 sc1
  buffer_load_dwordx4 v[212:215], v40, s[32:35], s66 offen offset:2304 sc1
  buffer_load_dwordx4 v[216:219], v49, s[32:35], s66 offen offset:0 sc1
  buffer_load_dwordx4 v[220:223], v49, s[32:35], s66 offen offset:2304 sc1
  buffer_load_dwordx4 v[224:227], v40, s[32:35], s67 offen offset:0 sc1
  buffer_load_dwordx4 v[228:231], v40, s[32:35], s67 offen offset:2304 sc1
  buffer_load_dwordx4 v[232:235], v49, s[32:35], s67 offen offset:0 sc1
  buffer_load_dwordx4 v[236:239], v49, s[32:35], s67 offen offset:2304 sc1
  s_waitcnt vmcnt(0)
  v_xor_b32 v32, v211, v6
  v_bitop3_b32 v32, v215, v6, v32 bitop3:0xbe
  v_bitop3_b32 v32, v219, v6, v32 bitop3:0xbe
  v_bitop3_b32 v32, v223, v6, v32 bitop3:0xbe
  v_bitop3_b32 v32, v227, v6, v32 bitop3:0xbe
  v_bitop3_b32 v32, v231, v6, v32 bitop3:0xbe
  v_bitop3_b32 v32, v235, v6, v32 bitop3:0xbe
  v_bitop3_b32 v32, v239, v6, v32 bitop3:0xbe
  v_cmp_ne_u32 vcc, 0, v32
  s_cbranch_vccz Lg_40d
  s_sub_u32 s50, s50, 1
  s_cbranch_scc0 Lg_40
  s_mov_b32 s50, 0
Lg_40d:
  v_perm_b32 v136, v210, v209, s63
  v_perm_b32 v136, v136, v208, s64
  v_perm_b32 v137, v214, v213, s63
  v_perm_b32 v137, v137, v212, s64
  v_perm_b32 v138, v218, v217, s63
  v_perm_b32 v138, v138, v216, s64
  v_perm_b32 v139, v222, v221, s63
  v_perm_b32 v139, v139, v220, s64
  v_perm_b32 v140, v226, v225, s63
  v_perm_b32 v140, v140, v224, s64
  v_perm_b32 v141, v230, v229, s63
  v_perm_b32 v141, v141, v228, s64
  v_perm_b32 v142, v234, v233, s63
  v_perm_b32 v142, v142, v232, s64
  v_perm_b32 v143, v238, v237, s63
  v_perm_b32 v143, v143, v236, s64
  v_pk_add_f32 v[208:209], v[208:209], v[212:213]
  v_pk_add_f32 v[208:209], v[208:209], v[216:217]
  v_pk_add_f32 v[208:209], v[208:209], v[220:221]
  v_pk_add_f32 v[208:209], v[208:209], v[224:225]
  v_pk_add_f32 v[208:209], v[208:209], v[228:229]
  v_pk_add_f32 v[208:209], v[208:209], v[232:233]
  v_pk_add_f32 v[208:209], v[208:209], v[236:237]
  v_pk_add_f32 v[136:137], v[136:137], v[138:139]
  v_pk_add_f32 v[136:137], v[136:137], v[140:141]
  v_pk_add_f32 v[136:137], v[136:137], v[142:143]
  v_add_f32 v33, v136, v137
  v_add_f32 v35, v210, v214
  v_add_f32 v35, v35, v218
  v_add_f32 v35, v35, v222
  v_add_f32 v35, v35, v226
  v_add_f32 v35, v35, v230
  v_add_f32 v35, v35, v234
  v_add_f32 v35, v35, v238
  v_cvt_pk_bf16_f32 v36, v208, v33
  v_cvt_pk_bf16_f32 v37, v209, v35
  v_lshlrev_b32 v28, 16, v36
  v_and_b32 v29, 0xffff0000, v36
  v_lshlrev_b32 v30, 16, v37
  v_and_b32 v31, 0xffff0000, v37
  v_pk_add_f32 v[28:29], v[28:29], v[50:51]
  v_pk_add_f32 v[30:31], v[30:31], v[52:53]
  v_cvt_pk_bf16_f32 v36, v28, v29
  v_cvt_pk_bf16_f32 v37, v30, v31
  s_mov_b32 exec_hi, 15
  ds_write_b64 v41, v[36:37] offset:3328
  v_lshlrev_b32 v28, 16, v36
  v_and_b32 v29, 0xffff0000, v36
  v_lshlrev_b32 v30, 16, v37
  v_and_b32 v31, 0xffff0000, v37
  v_readfirstlane_b32 s52, v28
  s_nop 1
  v_pk_add_f32 v[28:29], v[28:29], s[52:53] op_sel_hi:[1,0] neg_lo:[0,1] neg_hi:[0,1]
  v_pk_add_f32 v[30:31], v[30:31], s[52:53] op_sel_hi:[1,0] neg_lo:[0,1] neg_hi:[0,1]
  v_pk_mul_f32 v[32:33], v[28:29], v[28:29]
  v_pk_fma_f32 v[32:33], v[30:31], v[30:31], v[32:33]
  v_pk_add_f32 v[28:29], v[28:29], v[30:31]
  v_add_f32 v60, v28, v29
  v_add_f32 v61, v32, v33
  s_mov_b64 exec, -1
  v_add_f32_dpp v60, v60, v60 row_ror:8 row_mask:0xf bank_mask:0xf
  v_add_f32_dpp v61, v61, v61 row_ror:8 row_mask:0xf bank_mask:0xf
  s_nop 0
  v_add_f32_dpp v60, v60, v60 row_ror:4 row_mask:0xf bank_mask:0xf
  v_add_f32_dpp v61, v61, v61 row_ror:4 row_mask:0xf bank_mask:0xf
  s_nop 0
  v_add_f32_dpp v60, v60, v60 row_ror:2 row_mask:0xf bank_mask:0xf
  v_add_f32_dpp v61, v61, v61 row_ror:2 row_mask:0xf bank_mask:0xf
  s_nop 0
  v_add_f32_dpp v60, v60, v60 row_ror:1 row_mask:0xf bank_mask:0xf
  v_add_f32_dpp v61, v61, v61 row_ror:1 row_mask:0xf bank_mask:0xf
  v_mov_b32 v32, v60
  v_mov_b32 v33, v61
  s_nop 0
  v_permlane16_swap_b32 v60, v32
  v_permlane16_swap_b32 v61, v33
  v_add_f32 v60, v60, v32
  v_add_f32 v61, v61, v33
  v_mov_b32 v32, v60
  v_mov_b32 v33, v61
  s_nop 0
  v_permlane32_swap_b32 v60, v32
  v_permlane32_swap_b32 v61, v33
  v_add_f32 v60, v60, v32
  v_add_f32 v61, v61, v33
  v_mul_f32 v32, 0x3be38e39, v60
  v_fma_f32 v61, -v32, v60, v61
  v_add_f32 v60, s52, v32
  s_mov_b64 exec, 1
  ds_write_b64 v43, v[60:61] offset:5504
  ds_add_u32 v4, v5 offset:288
  s_mov_b64 exec, -1
Lw_41:
  ds_read_b32 v15, v4 offset:288
  s_waitcnt lgkmcnt(0)
  v_readfirstlane_b32 s51, v15
  s_nop 0
  s_cmp_ge_i32 s51, 4
  s_cbranch_scc1 Lw_41d
  s_sub_u32 s50, s50, 1
  s_cbranch_scc0 Lw_41
  s_mov_b32 s50, 0
Lw_41d:
  ds_read_b128 v[28:31], v4 offset:5504
  ds_read_b128 v[32:35], v4 offset:5520
  ds_read_b128 v[136:139], v42 offset:3328
  ds_read_b128 v[140:143], v42 offset:3392
  ds_read_b128 v[144:147], v42 offset:3456
  ds_read_b128 v[148:151], v42 offset:3520
  ds_read_b128 v[152:155], v42 offset:3584
  ds_read_b128 v[156:159], v42 offset:3648
  ds_read_b128 v[160:163], v42 offset:3712
  ds_read_b128 v[164:167], v42 offset:3776
  ds_read_b128 v[168:171], v42 offset:3840
  ds_read_b128 v[172:175], v42 offset:3904
  ds_read_b128 v[176:179], v42 offset:3968
  ds_read_b128 v[180:183], v42 offset:4032
  ds_read_b128 v[184:187], v42 offset:4096
  ds_read_b128 v[188:191], v42 offset:4160
  ds_read_b128 v[192:195], v42 offset:4224
  ds_read_b128 v[196:199], v42 offset:4288
  ds_read_b128 v[200:203], v42 offset:4352
  ds_read_b128 v[204:207], v42 offset:4416
  s_waitcnt lgkmcnt(15)
  v_mfma_f32_16x16x32_bf16 v[20:23], v[64:67], v[136:139], v[20:23]
  v_mfma_f32_16x16x32_bf16 v[20:23], v[68:71], v[140:143], v[20:23]
  v_add_f32 v36, v28, v30
  v_add_f32 v37, v32, v34
  s_waitcnt lgkmcnt(14)
  v_mfma_f32_16x16x32_bf16 v[20:23], v[72:75], v[144:147], v[20:23]
  v_add_f32 v36, v36, v37
  v_mul_f32 v36, 0x3e800000, v36
  v_mfma_f32_16x16x32_bf16 v[20:23], v[76:79], v[148:151], v[20:23]
  v_sub_f32 v28, v28, v36
  v_sub_f32 v30, v30, v36
  s_waitcnt lgkmcnt(12)
  v_mfma_f32_16x16x32_bf16 v[20:23], v[80:83], v[152:155], v[20:23]
  v_sub_f32 v32, v32, v36
  v_sub_f32 v34, v34, v36
  v_mfma_f32_16x16x32_bf16 v[20:23], v[84:87], v[156:159], v[20:23]
  v_mul_f32 v37, v28, v28
  v_fmac_f32 v37, v30, v30
  s_waitcnt lgkmcnt(10)
  v_mfma_f32_16x16x32_bf16 v[20:23], v[88:91], v[160:163], v[20:23]
  v_fmac_f32 v37, v32, v32
  v_fmac_f32 v37, v34, v34
  v_mfma_f32_16x16x32_bf16 v[20:23], v[92:95], v[164:167], v[20:23]
  v_add_f32 v29, v29, v31
  v_add_f32 v33, v33, v35
  s_waitcnt lgkmcnt(8)
  v_mfma_f32_16x16x32_bf16 v[20:23], v[96:99], v[168:171], v[20:23]
  v_add_f32 v29, v29, v33
  v_fmac_f32 v29, 0x43100000, v37
  v_mfma_f32_16x16x32_bf16 v[20:23], v[100:103], v[172:175], v[20:23]
  v_mul_f32 v37, 0x3ae38e39, v29
  v_max_f32 v37, 0, v37
  s_waitcnt lgkmcnt(6)
  v_mfma_f32_16x16x32_bf16 v[20:23], v[104:107], v[176:179], v[20:23]
  v_cvt_pk_bf16_f32 v38, v37, v36
  v_lshlrev_b32 v37, 16, v38
  v_mfma_f32_16x16x32_bf16 v[20:23], v[108:111], v[180:183], v[20:23]
  v_and_b32 v36, 0xffff0000, v38
  v_add_f32 v37, 0x3727c5ac, v37
  s_waitcnt lgkmcnt(4)
  v_mfma_f32_16x16x32_bf16 v[20:23], v[112:115], v[184:187], v[20:23]
  v_cvt_pk_bf16_f32 v38, v37, v37
  v_lshlrev_b32 v37, 16, v38
  v_mfma_f32_16x16x32_bf16 v[20:23], v[116:119], v[188:191], v[20:23]
  v_sqrt_f32 v37, v37
  v_nop
  s_waitcnt lgkmcnt(2)
  v_mfma_f32_16x16x32_bf16 v[20:23], v[120:123], v[192:195], v[20:23]
  v_cvt_pk_bf16_f32 v38, v37, v37
  v_lshlrev_b32 v37, 16, v38
  v_mfma_f32_16x16x32_bf16 v[20:23], v[124:127], v[196:199], v[20:23]
  v_rcp_f32 v37, v37
  s_waitcnt lgkmcnt(0)
  v_mfma_f32_16x16x32_bf16 v[20:23], v[128:131], v[200:203], v[20:23]
  s_waitcnt lgkmcnt(0)
  v_mfma_f32_16x16x32_bf16 v[20:23], v[132:135], v[204:207], v[20:23]
  s_nop 7
  v_pk_fma_f32 v[20:21], v[54:55], v[36:37], v[20:21] op_sel_hi:[1,0,1] neg_lo:[1,0,0] neg_hi:[1,0,0]
  v_pk_fma_f32 v[22:23], v[56:57], v[36:37], v[22:23] op_sel_hi:[1,0,1] neg_lo:[1,0,0] neg_hi:[1,0,0]
  v_pk_mul_f32 v[20:21], v[20:21], v[36:37] op_sel:[0,1] op_sel_hi:[1,1]
  v_pk_mul_f32 v[22:23], v[22:23], v[36:37] op_sel:[0,1] op_sel_hi:[1,1]
  v_cvt_pk_bf16_f32 v24, v20, v21
  v_lshlrev_b32 v20, 16, v24
  v_and_b32 v21, 0xffff0000, v24
  v_cvt_pk_bf16_f32 v25, v22, v23
  v_lshlrev_b32 v22, 16, v25
  v_and_b32 v23, 0xffff0000, v25
  s_cmp_eq_u32 s65, 0
  s_cselect_b32 exec_lo, 0, 0x000f000f
  s_cselect_b32 exec_hi, 0x000f000f, 0
  v_perm_b32 v24, v20, v21, s60
  v_perm_b32 v25, v22, v21, s61
  v_perm_b32 v26, v23, v21, s62
  v_mov_b32 v27, v6
  s_cmp_eq_u32 s45, 1
  s_cbranch_scc1 Ls_42p
  buffer_store_dwordx4 v[24:27], v62, s[32:35], s70 offen sc1
  s_branch Ls_42q
Ls_42p:
  buffer_store_dwordx4 v[24:27], v62, s[32:35], s70 offen
Ls_42q:
  s_mov_b64 exec, -1
  buffer_load_dwordx4 v[100:103], v44, s[32:35], s69 offen sc1
  s_mov_b32 s52, 0x22222222
  s_mov_b32 s53, 0x22222222
  s_mov_b32 s54, 0x44444444
  s_mov_b32 s55, 0x44444444
  s_mov_b32 s56, 0x88888888
  s_mov_b32 s57, 0x88888888
  s_cmp_eq_u32 s65, 0
  s_cselect_b64 s[58:59], 0, -1
  v_cndmask_b32 v34, v20, v21, s[52:53]
  v_cndmask_b32 v34, v34, v22, s[54:55]
  v_cndmask_b32 v34, v34, v23, s[56:57]
  v_mov_b32 v20, 0
  v_mov_b32 v21, 0
  v_mov_b32 v22, 0
  v_mov_b32 v23, 0
  s_cmp_ge_i32 s47, 230
  s_cbranch_scc1 Lw_44d
Lw_44:
  ds_read_b32 v15, v4 offset:0
  s_waitcnt lgkmcnt(0)
  v_readfirstlane_b32 s47, v15
  s_nop 0
  s_cmp_ge_i32 s47, 230
  s_cbranch_scc1 Lw_44d
  s_sub_u32 s50, s50, 1
  s_cbranch_scc0 Lw_44
  s_mov_b32 s50, 0
Lw_44d:
  ds_read_b64_tr_b16 v[64:65], v47 offset:0
  ds_read_b64_tr_b16 v[66:67], v48 offset:0
  ds_read_b64_tr_b16 v[68:69], v47 offset:4096
  ds_read_b64_tr_b16 v[70:71], v48 offset:4096
  ds_read_b64_tr_b16 v[72:73], v47 offset:8192
  ds_read_b64_tr_b16 v[74:75], v48 offset:8192
  s_cmp_ge_i32 s47, 242
  s_cbranch_scc1 Lw_45d
Lw_45:
  ds_read_b32 v15, v4 offset:0
  s_waitcnt lgkmcnt(0)
  v_readfirstlane_b32 s47, v15
  s_nop 0
  s_cmp_ge_i32 s47, 242
  s_cbranch_scc1 Lw_45d
  s_sub_u32 s50, s50, 1
  s_cbranch_scc0 Lw_45
  s_mov_b32 s50, 0
Lw_45d:
  ds_read_b64_tr_b16 v[76:77], v47 offset:12288
  ds_read_b64_tr_b16 v[78:79], v48 offset:12288
  ds_read_b64_tr_b16 v[80:81], v47 offset:16384
  ds_read_b64_tr_b16 v[82:83], v48 offset:16384
  ds_read_b64_tr_b16 v[84:85], v47 offset:20480
  ds_read_b64_tr_b16 v[86:87], v48 offset:20480
  s_cmp_ge_i32 s47, 254
  s_cbranch_scc1 Lw_46d
Lw_46:
  ds_read_b32 v15, v4 offset:0
  s_waitcnt lgkmcnt(0)
  v_readfirstlane_b32 s47, v15
  s_nop 0
  s_cmp_ge_i32 s47, 254
  s_cbranch_scc1 Lw_46d
  s_sub_u32 s50, s50, 1
  s_cbranch_scc0 Lw_46
  s_mov_b32 s50, 0
Lw_46d:
  ds_read_b64_tr_b16 v[88:89], v47 offset:24576
  ds_read_b64_tr_b16 v[90:91], v48 offset:24576
  ds_read_b64_tr_b16 v[92:93], v47 offset:28672
  ds_read_b64_tr_b16 v[94:95], v48 offset:28672
  ds_read_b64_tr_b16 v[96:97], v47 offset:32768
  ds_read_b64_tr_b16 v[98:99], v48 offset:32768
  buffer_load_dwordx4 v[104:107], v44, s[32:35], s69 offen sc1
Lr_43:
  s_waitcnt vmcnt(1)
  v_xor_b32 v35, v103, v6
  v_cmp_ne_u32 vcc, 0, v35
  s_cbranch_vccz Lr_43s0
  buffer_load_dwordx4 v[100:103], v44, s[32:35], s69 offen sc1
  s_waitcnt vmcnt(1)
  v_xor_b32 v35, v107, v6
  v_cmp_ne_u32 vcc, 0, v35
  s_cbranch_vccz Lr_43s1
  buffer_load_dwordx4 v[104:107], v44, s[32:35], s69 offen sc1
  s_sub_u32 s50, s50, 1
  s_cbranch_scc0 Lr_43
  s_mov_b32 s50, 0
Lr_43s0:
  v_mov_b32 v24, v100
  v_mov_b32 v25, v101
  v_mov_b32 v26, v102
  s_branch Lr_43j
Lr_43s1:
  v_mov_b32 v24, v104
  v_mov_b32 v25, v105
  v_mov_b32 v26, v106
Lr_43j:
  v_perm_b32 v28, v26, v25, s63
  v_perm_b32 v28, v28, v24, s64
  v_cndmask_b32 v35, v24, v28, s[52:53]
  v_cndmask_b32 v35, v35, v25, s[54:55]
  v_cndmask_b32 v35, v35, v26, s[56:57]
  v_and_b32 v35, 0xffff0000, v35
  v_cndmask_b32 v36, v34, v35, s[58:59]
  v_cndmask_b32 v37, v35, v34, s[58:59]
  v_mul_f32 v38, v36, v36
  v_mov_b32 v39, 1.0
  v_fmac_f32 v39, 0x3d372713, v38
  v_mul_f32 v39, v39, v36
  v_mul_f32 v39, 0xc0135761, v39
  v_exp_f32 v39, v39
  s_nop 0
  v_add_f32 v39, 1.0, v39
  v_rcp_f32 v39, v39
  s_nop 0
  v_mul_f32 v39, v39, v36
  v_cvt_pk_bf16_f32 v38, v39, v39
  v_lshlrev_b32 v39, 16, v38
  v_mul_f32 v39, v39, v37
  v_cvt_pk_bf16_f32 v39, v39, v39
  s_cmp_eq_u32 s65, 0
  s_cselect_b32 exec_lo, 0x000f000f, 0
  s_cselect_b32 exec_hi, 0, 0x000f000f
  ds_write_b16 v45, v39 offset:5568
  s_mov_b32 s52, 0x00010001
  s_mov_b32 s53, 0x00010001
  s_waitcnt lgkmcnt(0)
  s_mov_b64 exec, -1
  s_barrier
  ds_read_b128 v[24:27], v42 offset:5568
  v_mov_b32 v43, v6
  s_waitcnt lgkmcnt(0)
  v_cndmask_b32 v28, 0, v24, s[52:53]
  v_cndmask_b32 v29, 0, v25, s[52:53]
  v_cndmask_b32 v30, 0, v26, s[52:53]
  v_cndmask_b32 v31, 0, v27, s[52:53]
  s_lshl_b64 s[52:53], s[52:53], 1
  s_nop 0
  v_mfma_f32_16x16x32_bf16 v[20:23], v[64:67], v[28:31], v[20:23]
  v_cndmask_b32 v32, 0, v24, s[52:53]
  v_cndmask_b32 v33, 0, v25, s[52:53]
  v_cndmask_b32 v34, 0, v26, s[52:53]
  v_cndmask_b32 v35, 0, v27, s[52:53]
  s_lshl_b64 s[52:53], s[52:53], 1
  s_nop 0
  v_mfma_f32_16x16x32_bf16 v[20:23], v[68:71], v[32:35], v[20:23]
  v_cndmask_b32 v28, 0, v24, s[52:53]
  v_cndmask_b32 v29, 0, v25, s[52:53]
  v_cndmask_b32 v30, 0, v26, s[52:53]
  v_cndmask_b32 v31, 0, v27, s[52:53]
  s_lshl_b64 s[52:53], s[52:53], 1
  s_nop 0
  v_mfma_f32_16x16x32_bf16 v[20:23], v[72:75], v[28:31], v[20:23]
  v_cndmask_b32 v32, 0, v24, s[52:53]
  v_cndmask_b32 v33, 0, v25, s[52:53]
  v_cndmask_b32 v34, 0, v26, s[52:53]
  v_cndmask_b32 v35, 0, v27, s[52:53]
  s_lshl_b64 s[52:53], s[52:53], 1
  s_nop 0
  v_mfma_f32_16x16x32_bf16 v[20:23], v[76:79], v[32:35], v[20:23]
  v_cndmask_b32 v28, 0, v24, s[52:53]
  v_cndmask_b32 v29, 0, v25, s[52:53]
  v_cndmask_b32 v30, 0, v26, s[52:53]
  v_cndmask_b32 v31, 0, v27, s[52:53]
  s_lshl_b64 s[52:53], s[52:53], 1
  s_nop 0
  v_mfma_f32_16x16x32_bf16 v[20:23], v[80:83], v[28:31], v[20:23]
  v_cndmask_b32 v32, 0, v24, s[52:53]
  v_cndmask_b32 v33, 0, v25, s[52:53]
  v_cndmask_b32 v34, 0, v26, s[52:53]
  v_cndmask_b32 v35, 0, v27, s[52:53]
  s_lshl_b64 s[52:53], s[52:53], 1
  s_nop 0
  v_mfma_f32_16x16x32_bf16 v[20:23], v[84:87], v[32:35], v[20:23]
  v_cndmask_b32 v28, 0, v24, s[52:53]
  v_cndmask_b32 v29, 0, v25, s[52:53]
  v_cndmask_b32 v30, 0, v26, s[52:53]
  v_cndmask_b32 v31, 0, v27, s[52:53]
  s_lshl_b64 s[52:53], s[52:53], 1
  s_nop 0
  v_mfma_f32_16x16x32_bf16 v[20:23], v[88:91], v[28:31], v[20:23]
  v_cndmask_b32 v32, 0, v24, s[52:53]
  v_cndmask_b32 v33, 0, v25, s[52:53]
  v_cndmask_b32 v34, 0, v26, s[52:53]
  v_cndmask_b32 v35, 0, v27, s[52:53]
  s_lshl_b64 s[52:53], s[52:53], 1
  s_nop 0
  v_mfma_f32_16x16x32_bf16 v[20:23], v[92:95], v[32:35], v[20:23]
  v_cndmask_b32 v28, 0, v24, s[52:53]
  v_cndmask_b32 v29, 0, v25, s[52:53]
  v_cndmask_b32 v30, 0, v26, s[52:53]
  v_cndmask_b32 v31, 0, v27, s[52:53]
  s_nop 1
  v_mfma_f32_16x16x32_bf16 v[20:23], v[96:99], v[28:31], v[20:23]
  s_mov_b32 exec_lo, 0x01ff01ff
  s_mov_b32 exec_hi, 0x01ff01ff
  s_nop 5
  v_perm_b32 v40, v20, v21, s60
  v_perm_b32 v41, v22, v21, s61
  v_perm_b32 v42, v23, v21, s62
  buffer_store_dwordx4 v[40:43], v46, s[32:35], s68 offen sc1
  s_mov_b64 exec, -1
L_fin:
  s_waitcnt vmcnt(0)
L_end:
  s_endpgm
.section .rodata,"a"
.p2align 6

.amdhsa_kernel sequential_preLN__sliding_block_cached__glu_gated_geglu__decode_kernel
  .amdhsa_next_free_vgpr 256
  .amdhsa_next_free_sgpr 100
  .amdhsa_accum_offset 256
  .amdhsa_group_segment_fixed_size 0
  .amdhsa_kernarg_size 96
  .amdhsa_user_sgpr_count 2
  .amdhsa_user_sgpr_kernarg_segment_ptr 1
  .amdhsa_system_sgpr_workgroup_id_x 1
.end_amdhsa_kernel
```
